```python
import torch

def _softmax(x, axis=-1):
    return torch.softmax(x, dim=axis)
def _gelu(x):
    return torch.nn.functional.gelu(x, approximate="tanh")
def _silu(x):
    return torch.nn.functional.silu(x)
def _sigmoid(x):
    return torch.sigmoid(x)
def _layernorm(x, axis=-1, eps=1e-5):
    m = x.mean(dim=axis, keepdim=True)
    v = x.var(dim=axis, keepdim=True, unbiased=False)
    return (x - m) / torch.sqrt(v + eps)
def _scatter_add(tgt, idx, src, axis=0):
    return tgt.clone().index_add_(axis, idx, src)
def _segment_sum(src, seg, n):
    out = torch.zeros((n,) + src.shape[1:], dtype=src.dtype)
    return out.index_add_(0, seg, src)
def _pad(x, pw):
    flat = tuple(v for pair in reversed(pw) for v in pair)
    return torch.nn.functional.pad(x, flat)

kernel_name = 'standalone__glu_gated_reglu__prompt'

def setup_inputs():

    _w = (lambda a: (lambda t: t.to(torch.bfloat16) if t.is_floating_point() else t)(torch.as_tensor(a)))
    B, S, D, F = 1, 2048, 576, 4608
    return {
        "x": _w((lambda *s: torch.randn(*s, dtype=torch.bfloat16) * 0.05)(B, S, D)),
        "W_gate": _w((lambda *s: torch.randn(*s, dtype=torch.bfloat16) * 0.05)(D, F) * (2.0 / D) ** 0.5),
        "W_up": _w((lambda *s: torch.randn(*s, dtype=torch.bfloat16) * 0.05)(D, F) * (2.0 / D) ** 0.5),
        "W_down": _w((lambda *s: torch.randn(*s, dtype=torch.bfloat16) * 0.05)(F, D) * (1.0 / F) ** 0.5),
    }

def reference(x, W_gate, W_up, W_down):
    gate = torch.einsum("bsd,df->bsf", x, W_gate)
    up = torch.einsum("bsd,df->bsf", x, W_up)
    gate = gate * (lambda x, dt: x.to(dt))(gate > 0, gate.dtype)
    h = gate * up
    return torch.einsum("bsf,fd->bsd", h, W_down)
```

```asm
; @launch grid=(256,1,1) block=(256,1,1) lds=163840
.amdgcn_target "amdgcn-amd-amdhsa--gfx950"
.text
.globl standalone__glu_gated_reglu__prompt_kernel
.p2align 8
.type standalone__glu_gated_reglu__prompt_kernel,@function
standalone__glu_gated_reglu__prompt_kernel:
    s_cmp_ge_u32 s2, 256
    s_cbranch_scc1 K1_END
    s_load_dwordx4 s[88:91], s[0:1], 0
    s_load_dwordx4 s[92:95], s[0:1], 16
    s_load_dwordx4 s[96:99], s[0:1], 32
    s_load_dwordx2 s[100:101], s[0:1], 48
    s_memrealtime s[4:5]
    s_getpc_b64 s[30:31]
PCREF:
    v_lshlrev_b32 v2, 7, v0
    v_min_u32 v3, CODE_END-PCREF-4, v2
    global_load_dword v253, v3, s[30:31]
    v_add_u32 v2, 32768, v2
    v_min_u32 v3, CODE_END-PCREF-4, v2
    global_load_dword v253, v3, s[30:31]
    v_lshrrev_b32 v1, 6, v0
    v_and_b32 v179, 63, v0
    v_readfirstlane_b32 s32, v1
    s_and_b32 s67, s2, 7
    s_lshr_b32 s68, s2, 3
    s_and_b32 s33, s67, 1
    s_lshl_b32 s33, s33, 3
    s_lshr_b32 s69, s68, 2
    s_add_u32 s33, s33, s69
    s_lshr_b32 s35, s67, 1
    s_and_b32 s36, s68, 3
    s_lshl_b32 s34, s35, 2
    s_add_u32 s34, s34, s36
    v_lshrrev_b32 v168, 3, v179
    v_and_b32 v169, 7, v179
    v_lshrrev_b32 v170, 4, v179
    v_xor_b32 v171, v169, v170
    v_mul_u32_u24 v172, 1152, v168
    v_xor_b32 v173, 0, v171
    v_lshl_add_u32 v173, v173, 4, v172
    v_add_u32 v160, 0, v173
    v_xor_b32 v173, 4, v171
    v_lshl_add_u32 v173, v173, 4, v172
    v_add_u32 v161, 8192, v173
    v_xor_b32 v173, 0, v171
    v_lshl_add_u32 v173, v173, 4, v172
    v_add_u32 v162, 16384, v173
    v_xor_b32 v173, 4, v171
    v_lshl_add_u32 v173, v173, 4, v172
    v_add_u32 v163, 24576, v173
    s_lshl_b32 s67, s33, 7
    s_lshl_b32 s68, s32, 5
    s_add_u32 s67, s67, s68
    s_mul_i32 s65, s67, 1152
    s_mul_i32 s66, s32, 13312
    s_add_u32 s66, s66, 110592
    s_and_b32 s67, s34, 1
    s_mul_i32 s68, s34, 288
    s_lshl_b32 s69, s67, 5
    s_add_u32 s49, s68, s69
    s_xor_b32 s69, s67, 1
    s_lshl_b32 s69, s69, 8
    s_add_u32 s50, s68, s69
    v_and_b32 v171, 1, v170
    v_lshlrev_b32 v171, 2, v171
    v_xor_b32 v171, v171, v169
    v_lshlrev_b32 v171, 4, v171
    v_mul_u32_u24 v172, 9216, v168
    v_add_u32 v172, v172, v171
    v_add_u32 v1, 0, v172
    v_add_u32 v2, 72704, v172
    v_add_u32 v3, 145408, v172
    v_add_u32 v4, 218112, v172
    v_mul_u32_u24 v172, 1152, v168
    v_add_u32 v9, v172, v171
    s_mul_i32 s39, s32, 9216
    s_and_b32 s67, s32, 1
    s_mul_i32 s68, s67, 663552
    s_lshl_b32 s79, s49, 1
    s_add_u32 s37, s68, s79
    s_and_b32 s67, s33, 7
    s_mul_i32 s68, s67, 18
    s_and_b32 s69, s32, 1
    s_mul_i32 s69, s69, 9
    s_add_u32 s68, s68, s69
    v_min_u32 v255, 8, v179
    v_add_u32 v10, s68, v255
    v_mul_u32_u24 v10, 9216, v10
    v_lshlrev_b32 v255, 7, v255
    s_lshl_b32 s80, s50, 1
    s_and_b32 s70, s32, 1
    s_mul_i32 s68, s70, 1327104
    s_add_u32 s38, s68, s80
    s_and_b32 s80, s80, 0xffffff80
    s_lshl_b32 s67, s67, 2
    s_add_u32 s67, s67, s36
    s_lshl_b32 s67, s67, 2
    s_add_u32 s67, s67, s32
    s_mul_i32 s67, s67, 10368
    s_mul_i32 s68, s35, 1327104
    s_add_u32 s81, s67, s68
    s_lshl_b32 s67, s33, 7
    s_lshl_b32 s68, s36, 5
    s_add_u32 s67, s67, s68
    s_lshl_b32 s68, s32, 3
    s_add_u32 s67, s67, s68
    v_add_u32 v180, s67, v168
    v_mul_u32_u24 v180, 1152, v180
    v_and_b32 v173, 3, v179
    v_lshl_add_u32 v180, v173, 7, v180
    s_waitcnt lgkmcnt(0)
    s_mov_b32 s8, s88
    s_and_b32 s9, s89, 0xffff
    s_mov_b32 s10, 2359296
    s_mov_b32 s11, 0x00020000
    s_cmp_lt_u32 s32, 2
    s_cselect_b32 s67, s90, s92
    s_cselect_b32 s68, s91, s93
    s_mov_b32 s12, s67
    s_and_b32 s13, s68, 0xffff
    s_mov_b32 s14, 5308416
    s_mov_b32 s15, 0x00020000
    s_add_u32 m0, s66, 0
    s_add_u32 s62, s65, 0
    buffer_load_dwordx4 v160, s[8:11], s62 offen offset:0  lds
    s_mov_b32 s16, s94
    s_and_b32 s17, s95, 0xffff
    s_mov_b32 s18, 5308416
    s_mov_b32 s19, 0x00020000
    s_mov_b32 s20, s100
    buffer_load_dwordx4 v161, s[8:11], s62 offen offset:1024  lds
    s_and_b32 s21, s101, 0xffff
    s_mov_b32 s22, 31473664
    s_mov_b32 s23, 0x00020000
    s_mov_b32 s24, s96
    s_and_b32 s25, s97, 0xffff
    buffer_load_dwordx4 v162, s[8:11], s62 offen offset:2048  lds
    s_mov_b32 s26, 2359296
    s_mov_b32 s27, 0x00020000
    s_mov_b32 s28, s98
    s_and_b32 s29, s99, 0xffff
    s_mov_b32 s30, 256
    buffer_load_dwordx4 v163, s[8:11], s62 offen offset:3072  lds
    s_mov_b32 s31, 0x00020000
    v_lshrrev_b32 v178, 5, v179
    v_and_b32 v171, 31, v179
    v_mul_u32_u24 v11, 1152, v171
    v_lshl_add_u32 v11, v178, 4, v11
    s_add_u32 m0, s39, 0
    s_add_u32 s62, s37, 0
    buffer_load_dwordx4 v1, s[12:15], s62 offen offset:0  lds
    v_bfe_u32 v172, v179, 1, 3
    v_lshlrev_b32 v171, 7, v171
    v_add_u32 v171, s66, v171
    v_add_u32 v173, 0, v178
    v_xor_b32 v173, v173, v172
    buffer_load_dwordx4 v2, s[12:15], s62 offen offset:1024  lds
    v_lshl_add_u32 v164, v173, 4, v171
    v_add_u32 v173, 2, v178
    v_xor_b32 v173, v173, v172
    v_lshl_add_u32 v165, v173, 4, v171
    v_add_u32 v173, 4, v178
    buffer_load_dwordx4 v3, s[12:15], s62 offen offset:2048  lds
    v_xor_b32 v173, v173, v172
    v_lshl_add_u32 v166, v173, 4, v171
    v_add_u32 v173, 6, v178
    v_xor_b32 v173, v173, v172
    v_lshl_add_u32 v167, v173, 4, v171
    buffer_load_dwordx4 v4, s[12:15], s62 offen offset:3072  lds
    v_bfe_u32 v174, v179, 2, 2
    v_bfe_u32 v175, v179, 3, 1
    v_and_b32 v176, 3, v179
    v_lshlrev_b32 v254, 7, v176
    v_lshlrev_b32 v176, 3, v176
    s_add_u32 m0, s39, 4096
    s_add_u32 s62, s37, 294912
    buffer_load_dwordx4 v1, s[12:15], s62 offen offset:0  lds
    v_bfe_u32 v177, v179, 4, 1
    v_lshlrev_b32 v177, 5, v177
    v_add_u32 v176, v176, v177
    v_lshl_add_u32 v171, v178, 3, v174
    v_lshl_add_u32 v172, v171, 7, v176
    buffer_load_dwordx4 v2, s[12:15], s62 offen offset:1024  lds
    v_lshl_add_u32 v172, v175, 6, v172
    v_xor_b32 v173, 64, v172
    v_add_u32 v13, 0, v172
    v_add_u32 v14, 0, v173
    v_add_u32 v15, 36864, v172
    buffer_load_dwordx4 v3, s[12:15], s62 offen offset:2048  lds
    v_add_u32 v16, 36864, v173
    v_add_u32 v17, 73728, v172
    v_add_u32 v18, 73728, v173
    v_add_u32 v19, 110592, v172
    v_add_u32 v20, 110592, v173
    buffer_load_dwordx4 v4, s[12:15], s62 offen offset:3072  lds
    v_lshl_add_u32 v172, v171, 6, v176
    v_add_u32 v21, 36864, v172
    v_add_u32 v22, 73728, v172
    v_lshl_add_u32 v171, v178, 2, v174
    v_lshl_add_u32 v172, v171, 7, v176
    s_add_u32 m0, s39, 8192
    s_add_u32 s62, s37, 589824
    buffer_load_dwordx4 v1, s[12:15], s62 offen offset:0  lds
    v_lshl_add_u32 v172, v175, 6, v172
    s_and_b32 s70, s35, 1
    s_lshl_b32 s70, s70, 6
    v_xor_b32 v173, s70, v172
    v_xor_b32 v172, 64, v173
    s_add_u32 m0, s66, 4096
    s_add_u32 s62, s65, 128
    buffer_load_dwordx4 v160, s[8:11], s62 offen offset:0  lds
    v_add_u32 v23, 0, v172
    v_add_u32 v24, 0, v173
    v_add_u32 v25, 36864, v172
    v_add_u32 v26, 36864, v173
    v_add_u32 v27, 73728, v172
    buffer_load_dwordx4 v161, s[8:11], s62 offen offset:1024  lds
    v_add_u32 v28, 73728, v173
    v_add_u32 v29, 110592, v172
    v_add_u32 v30, 110592, v173
    v_lshrrev_b32 v171, 2, v179
    v_mul_u32_u24 v172, 9216, v171
    buffer_load_dwordx4 v162, s[8:11], s62 offen offset:2048  lds
    v_and_b32 v171, 3, v179
    v_lshl_add_u32 v172, v171, 4, v172
    v_add_u32 v5, 0, v172
    v_add_u32 v6, 146432, v172
    v_add_u32 v7, 292864, v172
    buffer_load_dwordx4 v163, s[8:11], s62 offen offset:3072  lds
    v_add_u32 v8, 439296, v172
    v_and_b32 v172, 15, v179
    v_mul_u32_u24 v12, 1152, v172
    v_and_b32 v173, 1, v170
    v_lshl_add_u32 v12, v173, 2, v12
    s_add_u32 m0, s66, 8192
    s_add_u32 s62, s65, 256
    buffer_load_dwordx4 v160, s[8:11], s62 offen offset:0  lds
    v_lshl_add_u32 v12, v178, 4, v12
    v_lshlrev_b32 v31, 10, v170
    v_lshl_add_u32 v31, v172, 4, v31
    v_lshlrev_b32 v0, 4, v179
    buffer_load_dwordx4 v161, s[8:11], s62 offen offset:1024  lds
    buffer_load_dwordx4 v162, s[8:11], s62 offen offset:2048  lds
    buffer_load_dwordx4 v163, s[8:11], s62 offen offset:3072  lds
    s_cmp_lg_u32 s32, 0
    s_cselect_b64 vcc, -1, 0
    s_or_b32 s67, s32, s2
    s_cmp_lg_u32 s67, 0
    s_cbranch_scc1 NOTOK
    s_lshl_b32 s67, s4, 3
    s_or_b32 s67, s67, 8
    v_mov_b32 v252, s67
    buffer_store_dword v252, off, s[28:31], 0 sc1
NOTOK:
    s_waitcnt vmcnt(17)
    ds_read_b128 a[0:3], v164 offset:0
    ds_read_b128 a[4:7], v165 offset:0
    ds_read_b128 a[8:11], v166 offset:0
    ds_read_b128 a[12:15], v167 offset:0
    s_waitcnt lgkmcnt(0)
    s_waitcnt vmcnt(8)
    s_barrier
    s_add_u32 m0, s39, 36864
    s_add_u32 s62, s37, 1327104
    buffer_load_dwordx4 v1, s[12:15], s62 offen offset:0  lds
    ds_read_b64_tr_b16 a[144:145], v13 offset:0
    ds_read_b64_tr_b16 a[146:147], v13 offset:512
    ds_read_b64_tr_b16 a[148:149], v14 offset:0
    ds_read_b64_tr_b16 a[150:151], v14 offset:512
    buffer_load_dwordx4 v2, s[12:15], s62 offen offset:1024  lds
    ds_read_b64_tr_b16 a[152:153], v13 offset:18432
    ds_read_b64_tr_b16 a[154:155], v13 offset:18944
    ds_read_b64_tr_b16 a[156:157], v14 offset:18432
    ds_read_b64_tr_b16 a[158:159], v14 offset:18944
    buffer_load_dwordx4 v3, s[12:15], s62 offen offset:2048  lds
    ds_read_b64_tr_b16 a[160:161], v13 offset:2048
    ds_read_b64_tr_b16 a[162:163], v13 offset:2560
    ds_read_b64_tr_b16 a[164:165], v14 offset:2048
    ds_read_b64_tr_b16 a[166:167], v14 offset:2560
    buffer_load_dwordx4 v4, s[12:15], s62 offen offset:3072  lds
    ds_read_b64_tr_b16 a[168:169], v13 offset:20480
    ds_read_b64_tr_b16 a[170:171], v13 offset:20992
    s_lshl_b32 s40, s32, 10
    s_add_u32 s70, s36, 0
    ds_read_b64_tr_b16 a[172:173], v14 offset:20480
    ds_read_b64_tr_b16 a[174:175], v14 offset:20992
    s_waitcnt lgkmcnt(8)
    v_mfma_f32_32x32x16_bf16 v[32:47], a[144:147], a[0:3], 0
    s_and_b32 s70, s70, 3
    s_lshl_b32 s63, s35, 2
    s_add_u32 m0, s39, 40960
    s_add_u32 s62, s37, 1622016
    buffer_load_dwordx4 v1, s[12:15], s62 offen offset:0  lds
    ds_read_b64_tr_b16 a[144:145], v13 offset:4096
    ds_read_b64_tr_b16 a[146:147], v13 offset:4608
    v_mfma_f32_32x32x16_bf16 v[48:63], a[148:151], a[0:3], 0
    s_add_u32 s70, s70, s63
    s_and_b32 s67, s70, 1
    ds_read_b64_tr_b16 a[148:149], v14 offset:4096
    ds_read_b64_tr_b16 a[150:151], v14 offset:4608
    v_mfma_f32_32x32x16_bf16 v[64:79], a[152:155], a[0:3], 0
    s_mul_i32 s68, s70, 288
    s_lshl_b32 s69, s67, 5
    buffer_load_dwordx4 v2, s[12:15], s62 offen offset:1024  lds
    s_add_u32 s64, s79, 128
    buffer_load_dword v253, v10, s[12:15], s64 offen
    ds_read_b64_tr_b16 a[152:153], v13 offset:22528
    ds_read_b64_tr_b16 a[154:155], v13 offset:23040
    v_mfma_f32_32x32x16_bf16 v[80:95], a[156:159], a[0:3], 0
    s_add_u32 s41, s68, s69
    s_xor_b32 s69, s67, 1
    s_waitcnt vmcnt(11)
    ds_read_b128 a[16:19], v164 offset:4096
    ds_read_b64_tr_b16 a[156:157], v14 offset:22528
    ds_read_b64_tr_b16 a[158:159], v14 offset:23040
    s_waitcnt lgkmcnt(9)
    v_mfma_f32_32x32x16_bf16 v[32:47], a[160:163], a[4:7], v[32:47]
    s_lshl_b32 s69, s69, 8
    s_add_u32 s45, s68, s69
    buffer_load_dwordx4 v3, s[12:15], s62 offen offset:2048  lds
    ds_read_b128 a[20:23], v165 offset:4096
    ds_read_b64_tr_b16 a[160:161], v13 offset:6144
    ds_read_b64_tr_b16 a[162:163], v13 offset:6656
    v_mfma_f32_32x32x16_bf16 v[48:63], a[164:167], a[4:7], v[48:63]
    s_lshl_b32 s67, s33, 4
    s_add_u32 s67, s67, s70
    ds_read_b128 a[24:27], v166 offset:4096
    ds_read_b64_tr_b16 a[164:165], v14 offset:6144
    ds_read_b64_tr_b16 a[166:167], v14 offset:6656
    v_mfma_f32_32x32x16_bf16 v[64:79], a[168:171], a[4:7], v[64:79]
    s_lshl_b32 s67, s67, 2
    s_add_u32 s67, s67, s32
    buffer_load_dwordx4 v4, s[12:15], s62 offen offset:3072  lds
    ds_read_b128 a[28:31], v167 offset:4096
    ds_read_b64_tr_b16 a[168:169], v13 offset:24576
    ds_read_b64_tr_b16 a[170:171], v13 offset:25088
    v_mfma_f32_32x32x16_bf16 v[80:95], a[172:175], a[4:7], v[80:95]
    s_mul_i32 s51, s67, 18432
    s_add_u32 s70, s36, 1
    ds_read_b64_tr_b16 a[172:173], v14 offset:24576
    ds_read_b64_tr_b16 a[174:175], v14 offset:25088
    s_waitcnt lgkmcnt(11)
    v_mfma_f32_32x32x16_bf16 v[32:47], a[144:147], a[8:11], v[32:47]
    s_and_b32 s70, s70, 3
    s_lshl_b32 s63, s35, 2
    s_add_u32 m0, s39, 45056
    s_add_u32 s62, s37, 1916928
    buffer_load_dwordx4 v1, s[12:15], s62 offen offset:0  lds
    ds_read_b64_tr_b16 a[144:145], v13 offset:8192
    ds_read_b64_tr_b16 a[146:147], v13 offset:8704
    v_mfma_f32_32x32x16_bf16 v[48:63], a[148:151], a[8:11], v[48:63]
    s_add_u32 s70, s70, s63
    s_and_b32 s67, s70, 1
    ds_read_b64_tr_b16 a[148:149], v14 offset:8192
    ds_read_b64_tr_b16 a[150:151], v14 offset:8704
    v_mfma_f32_32x32x16_bf16 v[64:79], a[152:155], a[8:11], v[64:79]
    s_mul_i32 s68, s70, 288
    s_lshl_b32 s69, s67, 5
    s_add_u32 m0, s66, 0
    s_add_u32 s62, s65, 384
    buffer_load_dwordx4 v160, s[8:11], s62 offen offset:0  lds
    ds_read_b64_tr_b16 a[152:153], v13 offset:26624
    ds_read_b64_tr_b16 a[154:155], v13 offset:27136
    v_mfma_f32_32x32x16_bf16 v[80:95], a[156:159], a[8:11], v[80:95]
    s_add_u32 s42, s68, s69
    s_xor_b32 s69, s67, 1
    ds_read_b64_tr_b16 a[156:157], v14 offset:26624
    ds_read_b64_tr_b16 a[158:159], v14 offset:27136
    s_waitcnt lgkmcnt(8)
    v_mfma_f32_32x32x16_bf16 v[32:47], a[160:163], a[12:15], v[32:47]
    s_lshl_b32 s69, s69, 8
    s_add_u32 s46, s68, s69
    buffer_load_dwordx4 v161, s[8:11], s62 offen offset:1024  lds
    ds_read_b64_tr_b16 a[160:161], v13 offset:10240
    ds_read_b64_tr_b16 a[162:163], v13 offset:10752
    v_mfma_f32_32x32x16_bf16 v[48:63], a[164:167], a[12:15], v[48:63]
    s_lshl_b32 s67, s33, 4
    s_add_u32 s67, s67, s70
    ds_read_b64_tr_b16 a[164:165], v14 offset:10240
    ds_read_b64_tr_b16 a[166:167], v14 offset:10752
    v_mfma_f32_32x32x16_bf16 v[64:79], a[168:171], a[12:15], v[64:79]
    s_lshl_b32 s67, s67, 2
    s_add_u32 s67, s67, s32
    buffer_load_dwordx4 v162, s[8:11], s62 offen offset:2048  lds
    ds_read_b64_tr_b16 a[168:169], v13 offset:28672
    ds_read_b64_tr_b16 a[170:171], v13 offset:29184
    v_mfma_f32_32x32x16_bf16 v[80:95], a[172:175], a[12:15], v[80:95]
    s_mul_i32 s52, s67, 18432
    s_add_u32 s70, s36, 2
    s_waitcnt vmcnt(13)
    ds_read_b128 a[32:35], v164 offset:8192
    ds_read_b64_tr_b16 a[172:173], v14 offset:28672
    ds_read_b64_tr_b16 a[174:175], v14 offset:29184
    s_waitcnt lgkmcnt(9)
    v_mfma_f32_32x32x16_bf16 v[32:47], a[144:147], a[16:19], v[32:47]
    s_and_b32 s70, s70, 3
    s_lshl_b32 s63, s35, 2
    buffer_load_dwordx4 v163, s[8:11], s62 offen offset:3072  lds
    ds_read_b128 a[36:39], v165 offset:8192
    ds_read_b64_tr_b16 a[144:145], v13 offset:12288
    ds_read_b64_tr_b16 a[146:147], v13 offset:12800
    v_mfma_f32_32x32x16_bf16 v[48:63], a[148:151], a[16:19], v[48:63]
    s_add_u32 s70, s70, s63
    s_and_b32 s67, s70, 1
    ds_read_b128 a[40:43], v166 offset:8192
    ds_read_b64_tr_b16 a[148:149], v14 offset:12288
    ds_read_b64_tr_b16 a[150:151], v14 offset:12800
    v_mfma_f32_32x32x16_bf16 v[64:79], a[152:155], a[16:19], v[64:79]
    s_mul_i32 s68, s70, 288
    s_lshl_b32 s69, s67, 5
    s_add_u32 m0, s66, 4096
    s_add_u32 s62, s65, 512
    buffer_load_dwordx4 v160, s[8:11], s62 offen offset:0  lds
    ds_read_b128 a[44:47], v167 offset:8192
    ds_read_b64_tr_b16 a[152:153], v13 offset:30720
    ds_read_b64_tr_b16 a[154:155], v13 offset:31232
    v_mfma_f32_32x32x16_bf16 v[80:95], a[156:159], a[16:19], v[80:95]
    s_add_u32 s43, s68, s69
    s_xor_b32 s69, s67, 1
    ds_read_b64_tr_b16 a[156:157], v14 offset:30720
    ds_read_b64_tr_b16 a[158:159], v14 offset:31232
    s_waitcnt lgkmcnt(11)
    v_mfma_f32_32x32x16_bf16 v[32:47], a[160:163], a[20:23], v[32:47]
    s_lshl_b32 s69, s69, 8
    s_add_u32 s47, s68, s69
    buffer_load_dwordx4 v161, s[8:11], s62 offen offset:1024  lds
    ds_read_b64_tr_b16 a[160:161], v13 offset:14336
    ds_read_b64_tr_b16 a[162:163], v13 offset:14848
    v_mfma_f32_32x32x16_bf16 v[48:63], a[164:167], a[20:23], v[48:63]
    s_lshl_b32 s67, s33, 4
    s_add_u32 s67, s67, s70
    ds_read_b64_tr_b16 a[164:165], v14 offset:14336
    ds_read_b64_tr_b16 a[166:167], v14 offset:14848
    v_mfma_f32_32x32x16_bf16 v[64:79], a[168:171], a[20:23], v[64:79]
    s_lshl_b32 s67, s67, 2
    s_add_u32 s67, s67, s32
    buffer_load_dwordx4 v162, s[8:11], s62 offen offset:2048  lds
    ds_read_b64_tr_b16 a[168:169], v13 offset:32768
    ds_read_b64_tr_b16 a[170:171], v13 offset:33280
    v_mfma_f32_32x32x16_bf16 v[80:95], a[172:175], a[20:23], v[80:95]
    s_mul_i32 s53, s67, 18432
    s_add_u32 s70, s36, 3
    ds_read_b64_tr_b16 a[172:173], v14 offset:32768
    ds_read_b64_tr_b16 a[174:175], v14 offset:33280
    s_waitcnt lgkmcnt(8)
    v_mfma_f32_32x32x16_bf16 v[32:47], a[144:147], a[24:27], v[32:47]
    s_and_b32 s70, s70, 3
    s_lshl_b32 s63, s35, 2
    buffer_load_dwordx4 v163, s[8:11], s62 offen offset:3072  lds
    ds_read_b64_tr_b16 a[144:145], v13 offset:16384
    ds_read_b64_tr_b16 a[146:147], v13 offset:16896
    v_mfma_f32_32x32x16_bf16 v[48:63], a[148:151], a[24:27], v[48:63]
    s_add_u32 s70, s70, s63
    s_and_b32 s67, s70, 1
    ds_read_b64_tr_b16 a[148:149], v14 offset:16384
    ds_read_b64_tr_b16 a[150:151], v14 offset:16896
    v_mfma_f32_32x32x16_bf16 v[64:79], a[152:155], a[24:27], v[64:79]
    s_mul_i32 s68, s70, 288
    s_lshl_b32 s69, s67, 5
    s_add_u32 m0, s39, 73728
    s_add_u32 s62, s37, 2654208
    buffer_load_dwordx4 v1, s[12:15], s62 offen offset:0  lds
    ds_read_b64_tr_b16 a[152:153], v13 offset:34816
    ds_read_b64_tr_b16 a[154:155], v13 offset:35328
    v_mfma_f32_32x32x16_bf16 v[80:95], a[156:159], a[24:27], v[80:95]
    s_add_u32 s44, s68, s69
    s_xor_b32 s69, s67, 1
    ds_read_b64_tr_b16 a[156:157], v14 offset:34816
    ds_read_b64_tr_b16 a[158:159], v14 offset:35328
    s_waitcnt lgkmcnt(8)
    v_mfma_f32_32x32x16_bf16 v[32:47], a[160:163], a[28:31], v[32:47]
    s_waitcnt vmcnt(9)
    s_barrier
    s_lshl_b32 s69, s69, 8
    s_add_u32 s48, s68, s69
    buffer_load_dwordx4 v2, s[12:15], s62 offen offset:1024  lds
    ds_read_b64_tr_b16 a[160:161], v15 offset:0
    ds_read_b64_tr_b16 a[162:163], v15 offset:512
    v_mfma_f32_32x32x16_bf16 v[48:63], a[164:167], a[28:31], v[48:63]
    s_lshl_b32 s67, s33, 4
    s_add_u32 s67, s67, s70
    s_add_u32 s64, s79, 1327232
    buffer_load_dword v253, v10, s[12:15], s64 offen
    ds_read_b64_tr_b16 a[164:165], v16 offset:0
    ds_read_b64_tr_b16 a[166:167], v16 offset:512
    v_mfma_f32_32x32x16_bf16 v[64:79], a[168:171], a[28:31], v[64:79]
    s_lshl_b32 s67, s67, 2
    s_add_u32 s67, s67, s32
    buffer_load_dwordx4 v3, s[12:15], s62 offen offset:2048  lds
    ds_read_b64_tr_b16 a[168:169], v15 offset:18432
    ds_read_b64_tr_b16 a[170:171], v15 offset:18944
    v_mfma_f32_32x32x16_bf16 v[80:95], a[172:175], a[28:31], v[80:95]
    s_mul_i32 s54, s67, 18432
    s_lshl_b32 s70, s32, 3
    ds_read_b64_tr_b16 a[172:173], v16 offset:18432
    ds_read_b64_tr_b16 a[174:175], v16 offset:18944
    s_waitcnt lgkmcnt(8)
    v_mfma_f32_32x32x16_bf16 v[32:47], a[144:147], a[32:35], v[32:47]
    s_lshl_b32 s63, s36, 8
    s_lshr_b32 s67, s35, 1
    buffer_load_dwordx4 v4, s[12:15], s62 offen offset:3072  lds
    ds_read_b64_tr_b16 a[144:145], v15 offset:2048
    ds_read_b64_tr_b16 a[146:147], v15 offset:2560
    v_mfma_f32_32x32x16_bf16 v[48:63], a[148:151], a[32:35], v[48:63]
    s_lshl_b32 s68, s67, 7
    s_add_u32 s63, s63, s68
    ds_read_b64_tr_b16 a[148:149], v16 offset:2048
    ds_read_b64_tr_b16 a[150:151], v16 offset:2560
    v_mfma_f32_32x32x16_bf16 v[64:79], a[152:155], a[32:35], v[64:79]
    s_lshl_b32 s68, s67, 8
    s_sub_u32 s3, 128, s68
    s_add_u32 m0, s39, 77824
    s_add_u32 s62, s37, 2949120
    buffer_load_dwordx4 v1, s[12:15], s62 offen offset:0  lds
    ds_read_b64_tr_b16 a[152:153], v15 offset:20480
    ds_read_b64_tr_b16 a[154:155], v15 offset:20992
    v_mfma_f32_32x32x16_bf16 v[80:95], a[156:159], a[32:35], v[80:95]
    s_barrier
    s_add_u32 s41, s41, s70
    s_mul_i32 s41, s41, 1152
    ds_read_b64_tr_b16 a[156:157], v16 offset:20480
    ds_read_b64_tr_b16 a[158:159], v16 offset:20992
    s_waitcnt lgkmcnt(8)
    v_mfma_f32_32x32x16_bf16 v[32:47], a[160:163], a[36:39], v[32:47]
    s_add_u32 s41, s41, s63
    s_add_u32 s42, s42, s70
    buffer_load_dwordx4 v2, s[12:15], s62 offen offset:1024  lds
    ds_read_b64_tr_b16 a[160:161], v15 offset:4096
    ds_read_b64_tr_b16 a[162:163], v15 offset:4608
    v_mfma_f32_32x32x16_bf16 v[48:63], a[164:167], a[36:39], v[48:63]
    s_mul_i32 s42, s42, 1152
    s_add_u32 s42, s42, s63
    s_waitcnt vmcnt(11)
    ds_read_b128 a[48:51], v164 offset:0
    ds_read_b64_tr_b16 a[164:165], v16 offset:4096
    ds_read_b64_tr_b16 a[166:167], v16 offset:4608
    v_mfma_f32_32x32x16_bf16 v[64:79], a[168:171], a[36:39], v[64:79]
    s_add_u32 s43, s43, s70
    s_mul_i32 s43, s43, 1152
    buffer_load_dwordx4 v3, s[12:15], s62 offen offset:2048  lds
    ds_read_b128 a[52:55], v165 offset:0
    ds_read_b64_tr_b16 a[168:169], v15 offset:22528
    ds_read_b64_tr_b16 a[170:171], v15 offset:23040
    v_mfma_f32_32x32x16_bf16 v[80:95], a[172:175], a[36:39], v[80:95]
    s_add_u32 s43, s43, s63
    s_add_u32 s44, s44, s70
    ds_read_b128 a[56:59], v166 offset:0
    ds_read_b64_tr_b16 a[172:173], v16 offset:22528
    ds_read_b64_tr_b16 a[174:175], v16 offset:23040
    s_waitcnt lgkmcnt(11)
    v_mfma_f32_32x32x16_bf16 v[32:47], a[144:147], a[40:43], v[32:47]
    s_mul_i32 s44, s44, 1152
    s_add_u32 s44, s44, s63
    buffer_load_dwordx4 v4, s[12:15], s62 offen offset:3072  lds
    ds_read_b128 a[60:63], v167 offset:0
    ds_read_b64_tr_b16 a[144:145], v15 offset:6144
    ds_read_b64_tr_b16 a[146:147], v15 offset:6656
    v_mfma_f32_32x32x16_bf16 v[48:63], a[148:151], a[40:43], v[48:63]
    s_add_u32 s45, s45, s70
    s_mul_i32 s45, s45, 1152
    ds_read_b64_tr_b16 a[148:149], v16 offset:6144
    ds_read_b64_tr_b16 a[150:151], v16 offset:6656
    v_mfma_f32_32x32x16_bf16 v[64:79], a[152:155], a[40:43], v[64:79]
    s_add_u32 s45, s45, s63
    s_add_u32 s46, s46, s70
    s_add_u32 m0, s39, 81920
    s_add_u32 s62, s37, 3244032
    buffer_load_dwordx4 v1, s[12:15], s62 offen offset:0  lds
    ds_read_b64_tr_b16 a[152:153], v15 offset:24576
    ds_read_b64_tr_b16 a[154:155], v15 offset:25088
    v_mfma_f32_32x32x16_bf16 v[80:95], a[156:159], a[40:43], v[80:95]
    s_mul_i32 s46, s46, 1152
    s_add_u32 s46, s46, s63
    ds_read_b64_tr_b16 a[156:157], v16 offset:24576
    ds_read_b64_tr_b16 a[158:159], v16 offset:25088
    s_waitcnt lgkmcnt(9)
    v_mfma_f32_32x32x16_bf16 v[32:47], a[160:163], a[44:47], v[32:47]
    s_add_u32 s47, s47, s70
    s_mul_i32 s47, s47, 1152
    s_add_u32 m0, s66, 8192
    s_add_u32 s62, s65, 640
    buffer_load_dwordx4 v160, s[8:11], s62 offen offset:0  lds
    ds_read_b64_tr_b16 a[160:161], v15 offset:8192
    ds_read_b64_tr_b16 a[162:163], v15 offset:8704
    v_mfma_f32_32x32x16_bf16 v[48:63], a[164:167], a[44:47], v[48:63]
    s_add_u32 s47, s47, s63
    s_add_u32 s48, s48, s70
    ds_read_b64_tr_b16 a[164:165], v16 offset:8192
    ds_read_b64_tr_b16 a[166:167], v16 offset:8704
    v_mfma_f32_32x32x16_bf16 v[64:79], a[168:171], a[44:47], v[64:79]
    s_mul_i32 s48, s48, 1152
    s_add_u32 s48, s48, s63
    buffer_load_dwordx4 v161, s[8:11], s62 offen offset:1024  lds
    ds_read_b64_tr_b16 a[168:169], v15 offset:26624
    ds_read_b64_tr_b16 a[170:171], v15 offset:27136
    v_mfma_f32_32x32x16_bf16 v[80:95], a[172:175], a[44:47], v[80:95]
    s_add_u32 s49, s49, s70
    s_mul_i32 s49, s49, 1152
    s_waitcnt vmcnt(12)
    ds_read_b128 a[64:67], v164 offset:4096
    ds_read_b64_tr_b16 a[172:173], v16 offset:26624
    ds_read_b64_tr_b16 a[174:175], v16 offset:27136
    s_waitcnt lgkmcnt(9)
    v_mfma_f32_32x32x16_bf16 v[32:47], a[144:147], a[48:51], v[32:47]
    s_add_u32 s50, s50, s70
    s_mul_i32 s50, s50, 1152
    buffer_load_dwordx4 v162, s[8:11], s62 offen offset:2048  lds
    ds_read_b128 a[68:71], v165 offset:4096
    ds_read_b64_tr_b16 a[144:145], v15 offset:10240
    ds_read_b64_tr_b16 a[146:147], v15 offset:10752
    v_mfma_f32_32x32x16_bf16 v[48:63], a[148:151], a[48:51], v[48:63]
    s_lshl_b32 s67, s33, 2
    s_add_u32 s67, s67, s36
    ds_read_b128 a[72:75], v166 offset:4096
    ds_read_b64_tr_b16 a[148:149], v16 offset:10240
    ds_read_b64_tr_b16 a[150:151], v16 offset:10752
    v_mfma_f32_32x32x16_bf16 v[64:79], a[152:155], a[48:51], v[64:79]
    s_lshl_b32 s70, s67, 7
    s_add_u32 s75, s70, 31465472
    buffer_load_dwordx4 v163, s[8:11], s62 offen offset:3072  lds
    ds_read_b128 a[76:79], v167 offset:4096
    ds_read_b64_tr_b16 a[152:153], v15 offset:28672
    ds_read_b64_tr_b16 a[154:155], v15 offset:29184
    v_mfma_f32_32x32x16_bf16 v[80:95], a[156:159], a[48:51], v[80:95]
    s_lshl_b32 s70, s35, 2
    s_add_u32 s77, s75, s70
    ds_read_b64_tr_b16 a[156:157], v16 offset:28672
    ds_read_b64_tr_b16 a[158:159], v16 offset:29184
    s_waitcnt lgkmcnt(11)
    v_mfma_f32_32x32x16_bf16 v[32:47], a[160:163], a[52:55], v[32:47]
    s_lshl_b32 s67, s67, 17
    s_lshl_b32 s68, s32, 11
    s_add_u32 m0, s66, 0
    s_add_u32 s62, s65, 768
    buffer_load_dwordx4 v160, s[8:11], s62 offen offset:0  lds
    ds_read_b64_tr_b16 a[160:161], v15 offset:12288
    ds_read_b64_tr_b16 a[162:163], v15 offset:12800
    v_mfma_f32_32x32x16_bf16 v[48:63], a[164:167], a[52:55], v[48:63]
    s_add_u32 s67, s67, s68
    s_add_u32 s67, s67, 18874368
    ds_read_b64_tr_b16 a[164:165], v16 offset:12288
    ds_read_b64_tr_b16 a[166:167], v16 offset:12800
    v_mfma_f32_32x32x16_bf16 v[64:79], a[168:171], a[52:55], v[64:79]
    s_lshl_b32 s68, s35, 15
    s_add_u32 s58, s67, s68
    buffer_load_dwordx4 v161, s[8:11], s62 offen offset:1024  lds
    ds_read_b64_tr_b16 a[168:169], v15 offset:30720
    ds_read_b64_tr_b16 a[170:171], v15 offset:31232
    v_mfma_f32_32x32x16_bf16 v[80:95], a[172:175], a[52:55], v[80:95]
    s_lshl_b32 s68, s35, 13
    s_add_u32 s67, s67, s68
    s_add_u32 s64, s79, 2654336
    buffer_load_dword v253, v10, s[12:15], s64 offen
    ds_read_b64_tr_b16 a[172:173], v16 offset:30720
    ds_read_b64_tr_b16 a[174:175], v16 offset:31232
    s_waitcnt lgkmcnt(8)
    v_mfma_f32_32x32x16_bf16 v[32:47], a[144:147], a[56:59], v[32:47]
    s_xor_b32 s68, s35, 3
    s_lshl_b32 s68, s68, 15
    buffer_load_dwordx4 v162, s[8:11], s62 offen offset:2048  lds
    ds_read_b64_tr_b16 a[144:145], v15 offset:14336
    ds_read_b64_tr_b16 a[146:147], v15 offset:14848
    v_mfma_f32_32x32x16_bf16 v[48:63], a[148:151], a[56:59], v[48:63]
    s_add_u32 s55, s67, s68
    s_xor_b32 s68, s35, 2
    ds_read_b64_tr_b16 a[148:149], v16 offset:14336
    ds_read_b64_tr_b16 a[150:151], v16 offset:14848
    v_mfma_f32_32x32x16_bf16 v[64:79], a[152:155], a[56:59], v[64:79]
    s_lshl_b32 s68, s68, 15
    s_add_u32 s56, s67, s68
    buffer_load_dwordx4 v163, s[8:11], s62 offen offset:3072  lds
    ds_read_b64_tr_b16 a[152:153], v15 offset:32768
    ds_read_b64_tr_b16 a[154:155], v15 offset:33280
    v_mfma_f32_32x32x16_bf16 v[80:95], a[156:159], a[56:59], v[80:95]
    s_xor_b32 s68, s35, 1
    s_lshl_b32 s68, s68, 15
    ds_read_b64_tr_b16 a[156:157], v16 offset:32768
    ds_read_b64_tr_b16 a[158:159], v16 offset:33280
    s_waitcnt lgkmcnt(8)
    v_mfma_f32_32x32x16_bf16 v[32:47], a[160:163], a[60:63], v[32:47]
    s_add_u32 s1, s67, s68
    s_lshl_b32 s67, s33, 4
    s_add_u32 m0, s39, 0
    s_add_u32 s62, s37, 3981312
    buffer_load_dwordx4 v1, s[12:15], s62 offen offset:0  lds
    ds_read_b64_tr_b16 a[160:161], v15 offset:16384
    ds_read_b64_tr_b16 a[162:163], v15 offset:16896
    v_mfma_f32_32x32x16_bf16 v[48:63], a[164:167], a[60:63], v[48:63]
    s_lshl_b32 s68, s32, 1
    s_add_u32 s68, s67, s68
    ds_read_b64_tr_b16 a[164:165], v16 offset:16384
    ds_read_b64_tr_b16 a[166:167], v16 offset:16896
    v_mfma_f32_32x32x16_bf16 v[64:79], a[168:171], a[60:63], v[64:79]
    s_lshl_b32 s68, s68, 4
    s_add_u32 s68, s68, s34
    buffer_load_dwordx4 v2, s[12:15], s62 offen offset:1024  lds
    ds_read_b64_tr_b16 a[168:169], v15 offset:34816
    ds_read_b64_tr_b16 a[170:171], v15 offset:35328
    v_mfma_f32_32x32x16_bf16 v[80:95], a[172:175], a[60:63], v[80:95]
    s_lshl_b32 s68, s68, 10
    s_add_u32 s57, s68, 27262976
    ds_read_b64_tr_b16 a[172:173], v16 offset:34816
    ds_read_b64_tr_b16 a[174:175], v16 offset:35328
    s_waitcnt lgkmcnt(8)
    v_mfma_f32_32x32x16_bf16 v[32:47], a[144:147], a[64:67], v[32:47]
    s_waitcnt vmcnt(11)
    s_barrier
    s_and_b32 s69, s35, 1
    s_lshl_b32 s69, s69, 17
    buffer_load_dwordx4 v3, s[12:15], s62 offen offset:2048  lds
    ds_read_b64_tr_b16 a[144:145], v17 offset:0
    ds_read_b64_tr_b16 a[146:147], v17 offset:512
    v_mfma_f32_32x32x16_bf16 v[48:63], a[148:151], a[64:67], v[48:63]
    s_add_u32 s0, s57, s69
    s_xor_b32 s69, s69, 0x20000
    ds_read_b64_tr_b16 a[148:149], v18 offset:0
    ds_read_b64_tr_b16 a[150:151], v18 offset:512
    v_mfma_f32_32x32x16_bf16 v[64:79], a[152:155], a[64:67], v[64:79]
    s_add_u32 s57, s57, s69
    s_add_u32 s70, s67, s34
    buffer_load_dwordx4 v4, s[12:15], s62 offen offset:3072  lds
    ds_read_b64_tr_b16 a[152:153], v17 offset:18432
    ds_read_b64_tr_b16 a[154:155], v17 offset:18944
    v_mfma_f32_32x32x16_bf16 v[80:95], a[156:159], a[64:67], v[80:95]
    s_lshl_b32 s68, s70, 14
    s_lshl_b32 s69, s32, 8
    ds_read_b64_tr_b16 a[156:157], v18 offset:18432
    ds_read_b64_tr_b16 a[158:159], v18 offset:18944
    s_waitcnt lgkmcnt(8)
    v_mfma_f32_32x32x16_bf16 v[32:47], a[160:163], a[68:71], v[32:47]
    s_add_u32 s68, s68, s69
    s_add_u32 s59, s68, 27262976
    s_add_u32 m0, s39, 4096
    s_add_u32 s62, s37, 4276224
    buffer_load_dwordx4 v1, s[12:15], s62 offen offset:0  lds
    ds_read_b64_tr_b16 a[160:161], v17 offset:2048
    ds_read_b64_tr_b16 a[162:163], v17 offset:2560
    v_mfma_f32_32x32x16_bf16 v[48:63], a[164:167], a[68:71], v[48:63]
    s_lshl_b32 s68, s33, 9
    s_add_u32 s74, s68, 31457280
    ds_read_b64_tr_b16 a[164:165], v18 offset:2048
    ds_read_b64_tr_b16 a[166:167], v18 offset:2560
    v_mfma_f32_32x32x16_bf16 v[64:79], a[168:171], a[68:71], v[64:79]
    s_lshl_b32 s68, s35, 7
    s_add_u32 s73, s74, s68
    buffer_load_dwordx4 v2, s[12:15], s62 offen offset:1024  lds
    ds_read_b64_tr_b16 a[168:169], v17 offset:20480
    ds_read_b64_tr_b16 a[170:171], v17 offset:20992
    v_mfma_f32_32x32x16_bf16 v[80:95], a[172:175], a[68:71], v[80:95]
    s_barrier
    s_lshl_b32 s68, s36, 2
    s_add_u32 s76, s73, s68
    s_waitcnt vmcnt(11)
    ds_read_b128 a[80:83], v164 offset:8192
    ds_read_b64_tr_b16 a[172:173], v18 offset:20480
    ds_read_b64_tr_b16 a[174:175], v18 offset:20992
    s_waitcnt lgkmcnt(9)
    v_mfma_f32_32x32x16_bf16 v[32:47], a[144:147], a[72:75], v[32:47]
    s_lshl_b32 s68, s36, 8
    s_add_u32 s60, s65, s68
    buffer_load_dwordx4 v3, s[12:15], s62 offen offset:2048  lds
    ds_read_b128 a[84:87], v165 offset:8192
    ds_read_b64_tr_b16 a[144:145], v17 offset:4096
    ds_read_b64_tr_b16 a[146:147], v17 offset:4608
    v_mfma_f32_32x32x16_bf16 v[48:63], a[148:151], a[72:75], v[48:63]
    s_lshl_b32 s68, s35, 6
    s_add_u32 s60, s60, s68
    ds_read_b128 a[88:91], v166 offset:8192
    ds_read_b64_tr_b16 a[148:149], v18 offset:4096
    ds_read_b64_tr_b16 a[150:151], v18 offset:4608
    v_mfma_f32_32x32x16_bf16 v[64:79], a[152:155], a[72:75], v[64:79]
    s_lshr_b32 s67, s34, 1
    s_and_b32 s67, s67, 3
    buffer_load_dwordx4 v4, s[12:15], s62 offen offset:3072  lds
    ds_read_b128 a[92:95], v167 offset:8192
    ds_read_b64_tr_b16 a[152:153], v17 offset:22528
    ds_read_b64_tr_b16 a[154:155], v17 offset:23040
    v_mfma_f32_32x32x16_bf16 v[80:95], a[156:159], a[72:75], v[80:95]
    s_lshl_b32 s67, s67, 5
    s_lshl_b32 s68, s33, 7
    ds_read_b64_tr_b16 a[156:157], v18 offset:22528
    ds_read_b64_tr_b16 a[158:159], v18 offset:23040
    s_waitcnt lgkmcnt(11)
    v_mfma_f32_32x32x16_bf16 v[32:47], a[160:163], a[76:79], v[32:47]
    s_add_u32 s67, s67, s68
    s_and_b32 s68, s32, 1
    s_add_u32 m0, s39, 8192
    s_add_u32 s62, s37, 4571136
    buffer_load_dwordx4 v1, s[12:15], s62 offen offset:0  lds
    ds_read_b64_tr_b16 a[160:161], v17 offset:6144
    ds_read_b64_tr_b16 a[162:163], v17 offset:6656
    v_mfma_f32_32x32x16_bf16 v[48:63], a[164:167], a[76:79], v[48:63]
    s_lshl_b32 s68, s68, 4
    s_add_u32 s67, s67, s68
    ds_read_b64_tr_b16 a[164:165], v18 offset:6144
    ds_read_b64_tr_b16 a[166:167], v18 offset:6656
    v_mfma_f32_32x32x16_bf16 v[64:79], a[168:171], a[76:79], v[64:79]
    s_mul_i32 s61, s67, 1152
    s_lshr_b32 s67, s34, 3
    s_add_u32 m0, s66, 4096
    s_add_u32 s62, s65, 896
    buffer_load_dwordx4 v160, s[8:11], s62 offen offset:0  lds
    ds_read_b64_tr_b16 a[168:169], v17 offset:24576
    ds_read_b64_tr_b16 a[170:171], v17 offset:25088
    v_mfma_f32_32x32x16_bf16 v[80:95], a[172:175], a[76:79], v[80:95]
    s_lshl_b32 s67, s67, 6
    s_add_u32 s61, s61, s67
    s_add_u32 s64, s79, 3981440
    buffer_load_dword v253, v10, s[12:15], s64 offen
    ds_read_b64_tr_b16 a[172:173], v18 offset:24576
    ds_read_b64_tr_b16 a[174:175], v18 offset:25088
    s_waitcnt lgkmcnt(8)
    v_mfma_f32_32x32x16_bf16 v[32:47], a[144:147], a[80:83], v[32:47]
    s_and_b32 s67, s34, 1
    s_lshl_b32 s67, s67, 5
    buffer_load_dwordx4 v161, s[8:11], s62 offen offset:1024  lds
    ds_read_b64_tr_b16 a[144:145], v17 offset:8192
    ds_read_b64_tr_b16 a[146:147], v17 offset:8704
    v_mfma_f32_32x32x16_bf16 v[48:63], a[148:151], a[80:83], v[48:63]
    s_add_u32 s61, s61, s67
    s_lshr_b32 s67, s32, 1
    ds_read_b64_tr_b16 a[148:149], v18 offset:8192
    ds_read_b64_tr_b16 a[150:151], v18 offset:8704
    v_mfma_f32_32x32x16_bf16 v[64:79], a[152:155], a[80:83], v[64:79]
    s_lshl_b32 s67, s67, 3
    s_add_u32 s61, s61, s67
    buffer_load_dwordx4 v162, s[8:11], s62 offen offset:2048  lds
    ds_read_b64_tr_b16 a[152:153], v17 offset:26624
    ds_read_b64_tr_b16 a[154:155], v17 offset:27136
    v_mfma_f32_32x32x16_bf16 v[80:95], a[156:159], a[80:83], v[80:95]
    s_add_u32 s61, s61, 1024
    s_waitcnt vmcnt(13)
    ds_read_b128 a[96:99], v164 offset:0
    ds_read_b64_tr_b16 a[156:157], v18 offset:26624
    ds_read_b64_tr_b16 a[158:159], v18 offset:27136
    s_waitcnt lgkmcnt(9)
    v_mfma_f32_32x32x16_bf16 v[32:47], a[160:163], a[84:87], v[32:47]
    buffer_load_dwordx4 v163, s[8:11], s62 offen offset:3072  lds
    ds_read_b128 a[100:103], v165 offset:0
    ds_read_b64_tr_b16 a[160:161], v17 offset:10240
    ds_read_b64_tr_b16 a[162:163], v17 offset:10752
    v_mfma_f32_32x32x16_bf16 v[48:63], a[164:167], a[84:87], v[48:63]
    ds_read_b128 a[104:107], v166 offset:0
    ds_read_b64_tr_b16 a[164:165], v18 offset:10240
    ds_read_b64_tr_b16 a[166:167], v18 offset:10752
    v_mfma_f32_32x32x16_bf16 v[64:79], a[168:171], a[84:87], v[64:79]
    s_add_u32 m0, s66, 8192
    s_add_u32 s62, s65, 1024
    buffer_load_dwordx4 v160, s[8:11], s62 offen offset:0  lds
    ds_read_b128 a[108:111], v167 offset:0
    ds_read_b64_tr_b16 a[168:169], v17 offset:28672
    ds_read_b64_tr_b16 a[170:171], v17 offset:29184
    v_mfma_f32_32x32x16_bf16 v[80:95], a[172:175], a[84:87], v[80:95]
    ds_read_b64_tr_b16 a[172:173], v18 offset:28672
    ds_read_b64_tr_b16 a[174:175], v18 offset:29184
    s_waitcnt lgkmcnt(11)
    v_mfma_f32_32x32x16_bf16 v[32:47], a[144:147], a[88:91], v[32:47]
    buffer_load_dwordx4 v161, s[8:11], s62 offen offset:1024  lds
    ds_read_b64_tr_b16 a[144:145], v17 offset:12288
    ds_read_b64_tr_b16 a[146:147], v17 offset:12800
    v_mfma_f32_32x32x16_bf16 v[48:63], a[148:151], a[88:91], v[48:63]
    ds_read_b64_tr_b16 a[148:149], v18 offset:12288
    ds_read_b64_tr_b16 a[150:151], v18 offset:12800
    v_mfma_f32_32x32x16_bf16 v[64:79], a[152:155], a[88:91], v[64:79]
    buffer_load_dwordx4 v162, s[8:11], s62 offen offset:2048  lds
    ds_read_b64_tr_b16 a[152:153], v17 offset:30720
    ds_read_b64_tr_b16 a[154:155], v17 offset:31232
    v_mfma_f32_32x32x16_bf16 v[80:95], a[156:159], a[88:91], v[80:95]
    ds_read_b64_tr_b16 a[156:157], v18 offset:30720
    ds_read_b64_tr_b16 a[158:159], v18 offset:31232
    s_waitcnt lgkmcnt(8)
    v_mfma_f32_32x32x16_bf16 v[32:47], a[160:163], a[92:95], v[32:47]
    buffer_load_dwordx4 v163, s[8:11], s62 offen offset:3072  lds
    ds_read_b64_tr_b16 a[160:161], v17 offset:14336
    ds_read_b64_tr_b16 a[162:163], v17 offset:14848
    v_mfma_f32_32x32x16_bf16 v[48:63], a[164:167], a[92:95], v[48:63]
    ds_read_b64_tr_b16 a[164:165], v18 offset:14336
    ds_read_b64_tr_b16 a[166:167], v18 offset:14848
    v_mfma_f32_32x32x16_bf16 v[64:79], a[168:171], a[92:95], v[64:79]
    s_add_u32 m0, s39, 36864
    s_add_u32 s62, s37, 128
    buffer_load_dwordx4 v1, s[12:15], s62 offen offset:0  lds
    ds_read_b64_tr_b16 a[168:169], v17 offset:32768
    ds_read_b64_tr_b16 a[170:171], v17 offset:33280
    v_mfma_f32_32x32x16_bf16 v[80:95], a[172:175], a[92:95], v[80:95]
    ds_read_b64_tr_b16 a[172:173], v18 offset:32768
    ds_read_b64_tr_b16 a[174:175], v18 offset:33280
    s_waitcnt lgkmcnt(8)
    v_mfma_f32_32x32x16_bf16 v[32:47], a[144:147], a[96:99], v[32:47]
    buffer_load_dwordx4 v2, s[12:15], s62 offen offset:1024  lds
    ds_read_b64_tr_b16 a[144:145], v17 offset:16384
    ds_read_b64_tr_b16 a[146:147], v17 offset:16896
    v_mfma_f32_32x32x16_bf16 v[48:63], a[148:151], a[96:99], v[48:63]
    ds_read_b64_tr_b16 a[148:149], v18 offset:16384
    ds_read_b64_tr_b16 a[150:151], v18 offset:16896
    v_mfma_f32_32x32x16_bf16 v[64:79], a[152:155], a[96:99], v[64:79]
    buffer_load_dwordx4 v3, s[12:15], s62 offen offset:2048  lds
    ds_read_b64_tr_b16 a[152:153], v17 offset:34816
    ds_read_b64_tr_b16 a[154:155], v17 offset:35328
    v_mfma_f32_32x32x16_bf16 v[80:95], a[156:159], a[96:99], v[80:95]
    ds_read_b64_tr_b16 a[156:157], v18 offset:34816
    ds_read_b64_tr_b16 a[158:159], v18 offset:35328
    s_waitcnt lgkmcnt(8)
    v_mfma_f32_32x32x16_bf16 v[32:47], a[160:163], a[100:103], v[32:47]
    s_waitcnt vmcnt(12)
    s_barrier
    buffer_load_dwordx4 v4, s[12:15], s62 offen offset:3072  lds
    ds_read_b64_tr_b16 a[160:161], v13 offset:0
    ds_read_b64_tr_b16 a[162:163], v13 offset:512
    v_mfma_f32_32x32x16_bf16 v[48:63], a[164:167], a[100:103], v[48:63]
    ds_read_b64_tr_b16 a[164:165], v14 offset:0
    ds_read_b64_tr_b16 a[166:167], v14 offset:512
    v_mfma_f32_32x32x16_bf16 v[64:79], a[168:171], a[100:103], v[64:79]
    s_add_u32 m0, s39, 40960
    s_add_u32 s62, s37, 295040
    buffer_load_dwordx4 v1, s[12:15], s62 offen offset:0  lds
    ds_read_b64_tr_b16 a[168:169], v13 offset:18432
    ds_read_b64_tr_b16 a[170:171], v13 offset:18944
    v_mfma_f32_32x32x16_bf16 v[80:95], a[172:175], a[100:103], v[80:95]
    s_waitcnt vmcnt(9)
    ds_read_b128 a[112:115], v164 offset:4096
    ds_read_b64_tr_b16 a[172:173], v14 offset:18432
    ds_read_b64_tr_b16 a[174:175], v14 offset:18944
    s_waitcnt lgkmcnt(9)
    v_mfma_f32_32x32x16_bf16 v[32:47], a[144:147], a[104:107], v[32:47]
    buffer_load_dwordx4 v2, s[12:15], s62 offen offset:1024  lds
    ds_read_b128 a[116:119], v165 offset:4096
    ds_read_b64_tr_b16 a[144:145], v13 offset:2048
    ds_read_b64_tr_b16 a[146:147], v13 offset:2560
    v_mfma_f32_32x32x16_bf16 v[48:63], a[148:151], a[104:107], v[48:63]
    ds_read_b128 a[120:123], v166 offset:4096
    ds_read_b64_tr_b16 a[148:149], v14 offset:2048
    ds_read_b64_tr_b16 a[150:151], v14 offset:2560
    v_mfma_f32_32x32x16_bf16 v[64:79], a[152:155], a[104:107], v[64:79]
    buffer_load_dwordx4 v3, s[12:15], s62 offen offset:2048  lds
    ds_read_b128 a[124:127], v167 offset:4096
    ds_read_b64_tr_b16 a[152:153], v13 offset:20480
    ds_read_b64_tr_b16 a[154:155], v13 offset:20992
    v_mfma_f32_32x32x16_bf16 v[80:95], a[156:159], a[104:107], v[80:95]
    s_barrier
    ds_read_b64_tr_b16 a[156:157], v14 offset:20480
    ds_read_b64_tr_b16 a[158:159], v14 offset:20992
    s_waitcnt lgkmcnt(11)
    v_mfma_f32_32x32x16_bf16 v[32:47], a[160:163], a[108:111], v[32:47]
    s_cbranch_vccnz W0_1
    buffer_load_dword v248, off, s[28:31], 0 sc1
W0_1:
    buffer_load_dwordx4 v4, s[12:15], s62 offen offset:3072  lds
    ds_read_b64_tr_b16 a[160:161], v13 offset:4096
    ds_read_b64_tr_b16 a[162:163], v13 offset:4608
    v_mfma_f32_32x32x16_bf16 v[48:63], a[164:167], a[108:111], v[48:63]
    ds_read_b64_tr_b16 a[164:165], v14 offset:4096
    ds_read_b64_tr_b16 a[166:167], v14 offset:4608
    v_mfma_f32_32x32x16_bf16 v[64:79], a[168:171], a[108:111], v[64:79]
    s_add_u32 m0, s39, 45056
    s_add_u32 s62, s37, 589952
    buffer_load_dwordx4 v1, s[12:15], s62 offen offset:0  lds
    ds_read_b64_tr_b16 a[168:169], v13 offset:22528
    ds_read_b64_tr_b16 a[170:171], v13 offset:23040
    v_mfma_f32_32x32x16_bf16 v[80:95], a[172:175], a[108:111], v[80:95]
    ds_read_b64_tr_b16 a[172:173], v14 offset:22528
    ds_read_b64_tr_b16 a[174:175], v14 offset:23040
    s_waitcnt lgkmcnt(8)
    v_mfma_f32_32x32x16_bf16 v[32:47], a[144:147], a[112:115], v[32:47]
    s_add_u32 m0, s39, 73728
    s_add_u32 s62, s37, 1327232
    buffer_load_dwordx4 v1, s[12:15], s62 offen offset:0  lds
    ds_read_b64_tr_b16 a[144:145], v13 offset:6144
    ds_read_b64_tr_b16 a[146:147], v13 offset:6656
    v_mfma_f32_32x32x16_bf16 v[48:63], a[148:151], a[112:115], v[48:63]
    ds_read_b64_tr_b16 a[148:149], v14 offset:6144
    ds_read_b64_tr_b16 a[150:151], v14 offset:6656
    v_mfma_f32_32x32x16_bf16 v[64:79], a[152:155], a[112:115], v[64:79]
    buffer_load_dwordx4 v2, s[12:15], s62 offen offset:1024  lds
    ds_read_b64_tr_b16 a[152:153], v13 offset:24576
    ds_read_b64_tr_b16 a[154:155], v13 offset:25088
    v_mfma_f32_32x32x16_bf16 v[80:95], a[156:159], a[112:115], v[80:95]
    s_waitcnt vmcnt(11)
    ds_read_b128 a[128:131], v164 offset:8192
    ds_read_b64_tr_b16 a[156:157], v14 offset:24576
    ds_read_b64_tr_b16 a[158:159], v14 offset:25088
    s_waitcnt lgkmcnt(9)
    v_mfma_f32_32x32x16_bf16 v[32:47], a[160:163], a[116:119], v[32:47]
    buffer_load_dwordx4 v3, s[12:15], s62 offen offset:2048  lds
    ds_read_b128 a[132:135], v165 offset:8192
    ds_read_b64_tr_b16 a[160:161], v13 offset:8192
    ds_read_b64_tr_b16 a[162:163], v13 offset:8704
    v_mfma_f32_32x32x16_bf16 v[48:63], a[164:167], a[116:119], v[48:63]
    ds_read_b128 a[136:139], v166 offset:8192
    ds_read_b64_tr_b16 a[164:165], v14 offset:8192
    ds_read_b64_tr_b16 a[166:167], v14 offset:8704
    v_mfma_f32_32x32x16_bf16 v[64:79], a[168:171], a[116:119], v[64:79]
    buffer_load_dwordx4 v4, s[12:15], s62 offen offset:3072  lds
    ds_read_b128 a[140:143], v167 offset:8192
    ds_read_b64_tr_b16 a[168:169], v13 offset:26624
    ds_read_b64_tr_b16 a[170:171], v13 offset:27136
    v_mfma_f32_32x32x16_bf16 v[80:95], a[172:175], a[116:119], v[80:95]
    ds_read_b64_tr_b16 a[172:173], v14 offset:26624
    ds_read_b64_tr_b16 a[174:175], v14 offset:27136
    s_waitcnt lgkmcnt(11)
    v_mfma_f32_32x32x16_bf16 v[32:47], a[144:147], a[120:123], v[32:47]
    s_add_u32 m0, s39, 77824
    s_add_u32 s62, s37, 1622144
    buffer_load_dwordx4 v1, s[12:15], s62 offen offset:0  lds
    ds_read_b64_tr_b16 a[144:145], v13 offset:10240
    ds_read_b64_tr_b16 a[146:147], v13 offset:10752
    v_mfma_f32_32x32x16_bf16 v[48:63], a[148:151], a[120:123], v[48:63]
    ds_read_b64_tr_b16 a[148:149], v14 offset:10240
    ds_read_b64_tr_b16 a[150:151], v14 offset:10752
    v_mfma_f32_32x32x16_bf16 v[64:79], a[152:155], a[120:123], v[64:79]
    buffer_load_dwordx4 v2, s[12:15], s62 offen offset:1024  lds
    ds_read_b64_tr_b16 a[152:153], v13 offset:28672
    ds_read_b64_tr_b16 a[154:155], v13 offset:29184
    v_mfma_f32_32x32x16_bf16 v[80:95], a[156:159], a[120:123], v[80:95]
    ds_read_b64_tr_b16 a[156:157], v14 offset:28672
    ds_read_b64_tr_b16 a[158:159], v14 offset:29184
    s_waitcnt lgkmcnt(8)
    v_mfma_f32_32x32x16_bf16 v[32:47], a[160:163], a[124:127], v[32:47]
    buffer_load_dwordx4 v3, s[12:15], s62 offen offset:2048  lds
    ds_read_b64_tr_b16 a[160:161], v13 offset:12288
    ds_read_b64_tr_b16 a[162:163], v13 offset:12800
    v_mfma_f32_32x32x16_bf16 v[48:63], a[164:167], a[124:127], v[48:63]
    ds_read_b64_tr_b16 a[164:165], v14 offset:12288
    ds_read_b64_tr_b16 a[166:167], v14 offset:12800
    v_mfma_f32_32x32x16_bf16 v[64:79], a[168:171], a[124:127], v[64:79]
    buffer_load_dwordx4 v4, s[12:15], s62 offen offset:3072  lds
    ds_read_b64_tr_b16 a[168:169], v13 offset:30720
    ds_read_b64_tr_b16 a[170:171], v13 offset:31232
    v_mfma_f32_32x32x16_bf16 v[80:95], a[172:175], a[124:127], v[80:95]
    ds_read_b64_tr_b16 a[172:173], v14 offset:30720
    ds_read_b64_tr_b16 a[174:175], v14 offset:31232
    s_waitcnt lgkmcnt(8)
    v_mfma_f32_32x32x16_bf16 v[32:47], a[144:147], a[128:131], v[32:47]
    s_add_u32 m0, s39, 81920
    s_add_u32 s62, s37, 1917056
    buffer_load_dwordx4 v1, s[12:15], s62 offen offset:0  lds
    ds_read_b64_tr_b16 a[144:145], v13 offset:14336
    ds_read_b64_tr_b16 a[146:147], v13 offset:14848
    v_mfma_f32_32x32x16_bf16 v[48:63], a[148:151], a[128:131], v[48:63]
    ds_read_b64_tr_b16 a[148:149], v14 offset:14336
    ds_read_b64_tr_b16 a[150:151], v14 offset:14848
    v_mfma_f32_32x32x16_bf16 v[64:79], a[152:155], a[128:131], v[64:79]
    ds_read_b64_tr_b16 a[152:153], v13 offset:32768
    ds_read_b64_tr_b16 a[154:155], v13 offset:33280
    v_mfma_f32_32x32x16_bf16 v[80:95], a[156:159], a[128:131], v[80:95]
    ds_read_b64_tr_b16 a[156:157], v14 offset:32768
    ds_read_b64_tr_b16 a[158:159], v14 offset:33280
    s_waitcnt lgkmcnt(8)
    v_mfma_f32_32x32x16_bf16 v[32:47], a[160:163], a[132:135], v[32:47]
    ds_read_b64_tr_b16 a[160:161], v13 offset:16384
    ds_read_b64_tr_b16 a[162:163], v13 offset:16896
    v_mfma_f32_32x32x16_bf16 v[48:63], a[164:167], a[132:135], v[48:63]
    ds_read_b64_tr_b16 a[164:165], v14 offset:16384
    ds_read_b64_tr_b16 a[166:167], v14 offset:16896
    v_mfma_f32_32x32x16_bf16 v[64:79], a[168:171], a[132:135], v[64:79]
    ds_read_b64_tr_b16 a[168:169], v13 offset:34816
    ds_read_b64_tr_b16 a[170:171], v13 offset:35328
    v_mfma_f32_32x32x16_bf16 v[80:95], a[172:175], a[132:135], v[80:95]
    ds_read_b64_tr_b16 a[172:173], v14 offset:34816
    ds_read_b64_tr_b16 a[174:175], v14 offset:35328
    s_waitcnt lgkmcnt(8)
    v_mfma_f32_32x32x16_bf16 v[32:47], a[144:147], a[136:139], v[32:47]
    s_waitcnt vmcnt(9)
    s_barrier
    ds_read_b64_tr_b16 a[144:145], v15 offset:0
    ds_read_b64_tr_b16 a[146:147], v15 offset:512
    v_mfma_f32_32x32x16_bf16 v[48:63], a[148:151], a[136:139], v[48:63]
    ds_read_b64_tr_b16 a[148:149], v16 offset:0
    ds_read_b64_tr_b16 a[150:151], v16 offset:512
    v_mfma_f32_32x32x16_bf16 v[64:79], a[152:155], a[136:139], v[64:79]
    ds_read_b64_tr_b16 a[152:153], v15 offset:18432
    ds_read_b64_tr_b16 a[154:155], v15 offset:18944
    v_mfma_f32_32x32x16_bf16 v[80:95], a[156:159], a[136:139], v[80:95]
    ds_read_b64_tr_b16 a[156:157], v16 offset:18432
    ds_read_b64_tr_b16 a[158:159], v16 offset:18944
    s_waitcnt lgkmcnt(8)
    v_mfma_f32_32x32x16_bf16 v[32:47], a[160:163], a[140:143], v[32:47]
    ds_read_b64_tr_b16 a[160:161], v15 offset:2048
    ds_read_b64_tr_b16 a[162:163], v15 offset:2560
    v_mfma_f32_32x32x16_bf16 v[48:63], a[164:167], a[140:143], v[48:63]
    ds_read_b64_tr_b16 a[164:165], v16 offset:2048
    ds_read_b64_tr_b16 a[166:167], v16 offset:2560
    v_mfma_f32_32x32x16_bf16 v[64:79], a[168:171], a[140:143], v[64:79]
    ds_read_b64_tr_b16 a[168:169], v15 offset:20480
    ds_read_b64_tr_b16 a[170:171], v15 offset:20992
    v_mfma_f32_32x32x16_bf16 v[80:95], a[172:175], a[140:143], v[80:95]
    s_barrier
    ds_read_b64_tr_b16 a[172:173], v16 offset:20480
    ds_read_b64_tr_b16 a[174:175], v16 offset:20992
    s_waitcnt lgkmcnt(8)
    v_mfma_f32_32x32x16_bf16 v[96:111], a[144:147], a[0:3], 0
    s_add_u32 m0, s39, 110592
    s_add_u32 s62, s37, 2654336
    buffer_load_dwordx4 v1, s[12:15], s62 offen offset:0  lds
    ds_read_b64_tr_b16 a[144:145], v15 offset:4096
    ds_read_b64_tr_b16 a[146:147], v15 offset:4608
    v_mfma_f32_32x32x16_bf16 v[112:127], a[148:151], a[0:3], 0
    ds_read_b64_tr_b16 a[148:149], v16 offset:4096
    ds_read_b64_tr_b16 a[150:151], v16 offset:4608
    v_mfma_f32_32x32x16_bf16 v[128:143], a[152:155], a[0:3], 0
    buffer_load_dwordx4 v2, s[12:15], s62 offen offset:1024  lds
    ds_read_b64_tr_b16 a[152:153], v15 offset:22528
    ds_read_b64_tr_b16 a[154:155], v15 offset:23040
    v_mfma_f32_32x32x16_bf16 v[144:159], a[156:159], a[0:3], 0
    ds_read_b64_tr_b16 a[156:157], v16 offset:22528
    ds_read_b64_tr_b16 a[158:159], v16 offset:23040
    s_waitcnt lgkmcnt(8)
    v_mfma_f32_32x32x16_bf16 v[96:111], a[160:163], a[4:7], v[96:111]
    buffer_load_dwordx4 v3, s[12:15], s62 offen offset:2048  lds
    v_max_f32 v32, 0, v32
    ds_read_b64_tr_b16 a[160:161], v15 offset:6144
    ds_read_b64_tr_b16 a[162:163], v15 offset:6656
    v_mfma_f32_32x32x16_bf16 v[112:127], a[164:167], a[4:7], v[112:127]
    v_max_f32 v33, 0, v33
    ds_read_b64_tr_b16 a[164:165], v16 offset:6144
    ds_read_b64_tr_b16 a[166:167], v16 offset:6656
    v_mfma_f32_32x32x16_bf16 v[128:143], a[168:171], a[4:7], v[128:143]
    buffer_load_dwordx4 v4, s[12:15], s62 offen offset:3072  lds
    v_mul_f32 v32, v32, v64
    ds_read_b64_tr_b16 a[168:169], v15 offset:24576
    ds_read_b64_tr_b16 a[170:171], v15 offset:25088
    v_mfma_f32_32x32x16_bf16 v[144:159], a[172:175], a[4:7], v[144:159]
    v_mul_f32 v33, v33, v65
    ds_read_b64_tr_b16 a[172:173], v16 offset:24576
    ds_read_b64_tr_b16 a[174:175], v16 offset:25088
    s_waitcnt lgkmcnt(8)
    v_mfma_f32_32x32x16_bf16 v[96:111], a[144:147], a[8:11], v[96:111]
    s_add_u32 m0, s39, 114688
    s_add_u32 s62, s37, 2949248
    buffer_load_dwordx4 v1, s[12:15], s62 offen offset:0  lds
    v_cvt_pk_bf16_f32 v160, v32, v33
    ds_read_b64_tr_b16 a[144:145], v15 offset:8192
    ds_read_b64_tr_b16 a[146:147], v15 offset:8704
    v_mfma_f32_32x32x16_bf16 v[112:127], a[148:151], a[8:11], v[112:127]
    v_max_f32 v34, 0, v34
    ds_read_b64_tr_b16 a[148:149], v16 offset:8192
    ds_read_b64_tr_b16 a[150:151], v16 offset:8704
    v_mfma_f32_32x32x16_bf16 v[128:143], a[152:155], a[8:11], v[128:143]
    buffer_load_dwordx4 v2, s[12:15], s62 offen offset:1024  lds
    v_max_f32 v35, 0, v35
    ds_read_b64_tr_b16 a[152:153], v15 offset:26624
    ds_read_b64_tr_b16 a[154:155], v15 offset:27136
    v_mfma_f32_32x32x16_bf16 v[144:159], a[156:159], a[8:11], v[144:159]
    v_mul_f32 v34, v34, v66
    ds_read_b64_tr_b16 a[156:157], v16 offset:26624
    ds_read_b64_tr_b16 a[158:159], v16 offset:27136
    s_waitcnt lgkmcnt(8)
    v_mfma_f32_32x32x16_bf16 v[96:111], a[160:163], a[12:15], v[96:111]
    buffer_load_dwordx4 v3, s[12:15], s62 offen offset:2048  lds
    v_mul_f32 v35, v35, v67
    ds_read_b64_tr_b16 a[160:161], v15 offset:10240
    ds_read_b64_tr_b16 a[162:163], v15 offset:10752
    v_mfma_f32_32x32x16_bf16 v[112:127], a[164:167], a[12:15], v[112:127]
    v_cvt_pk_bf16_f32 v161, v34, v35
    ds_read_b64_tr_b16 a[164:165], v16 offset:10240
    ds_read_b64_tr_b16 a[166:167], v16 offset:10752
    v_mfma_f32_32x32x16_bf16 v[128:143], a[168:171], a[12:15], v[128:143]
    buffer_load_dwordx4 v4, s[12:15], s62 offen offset:3072  lds
    v_max_f32 v36, 0, v36
    ds_read_b64_tr_b16 a[168:169], v15 offset:28672
    ds_read_b64_tr_b16 a[170:171], v15 offset:29184
    v_mfma_f32_32x32x16_bf16 v[144:159], a[172:175], a[12:15], v[144:159]
    v_max_f32 v37, 0, v37
    ds_read_b64_tr_b16 a[172:173], v16 offset:28672
    ds_read_b64_tr_b16 a[174:175], v16 offset:29184
    s_waitcnt lgkmcnt(8)
    v_mfma_f32_32x32x16_bf16 v[96:111], a[144:147], a[16:19], v[96:111]
    s_add_u32 m0, s39, 118784
    s_add_u32 s62, s37, 3244160
    buffer_load_dwordx4 v1, s[12:15], s62 offen offset:0  lds
    v_mul_f32 v36, v36, v68
    ds_read_b64_tr_b16 a[144:145], v15 offset:12288
    ds_read_b64_tr_b16 a[146:147], v15 offset:12800
    v_mfma_f32_32x32x16_bf16 v[112:127], a[148:151], a[16:19], v[112:127]
    v_mul_f32 v37, v37, v69
    ds_read_b64_tr_b16 a[148:149], v16 offset:12288
    ds_read_b64_tr_b16 a[150:151], v16 offset:12800
    v_mfma_f32_32x32x16_bf16 v[128:143], a[152:155], a[16:19], v[128:143]
    s_add_u32 m0, s39, 0
    s_add_u32 s62, s37, 3981440
    buffer_load_dwordx4 v1, s[12:15], s62 offen offset:0  lds
    v_cvt_pk_bf16_f32 v162, v36, v37
    ds_read_b64_tr_b16 a[152:153], v15 offset:30720
    ds_read_b64_tr_b16 a[154:155], v15 offset:31232
    v_mfma_f32_32x32x16_bf16 v[144:159], a[156:159], a[16:19], v[144:159]
    v_max_f32 v38, 0, v38
    ds_read_b64_tr_b16 a[156:157], v16 offset:30720
    ds_read_b64_tr_b16 a[158:159], v16 offset:31232
    s_waitcnt lgkmcnt(8)
    v_mfma_f32_32x32x16_bf16 v[96:111], a[160:163], a[20:23], v[96:111]
    buffer_load_dwordx4 v2, s[12:15], s62 offen offset:1024  lds
    v_max_f32 v39, 0, v39
    ds_read_b64_tr_b16 a[160:161], v15 offset:14336
    ds_read_b64_tr_b16 a[162:163], v15 offset:14848
    v_mfma_f32_32x32x16_bf16 v[112:127], a[164:167], a[20:23], v[112:127]
    v_mul_f32 v38, v38, v70
    ds_read_b64_tr_b16 a[164:165], v16 offset:14336
    ds_read_b64_tr_b16 a[166:167], v16 offset:14848
    v_mfma_f32_32x32x16_bf16 v[128:143], a[168:171], a[20:23], v[128:143]
    buffer_load_dwordx4 v3, s[12:15], s62 offen offset:2048  lds
    v_mul_f32 v39, v39, v71
    ds_read_b64_tr_b16 a[168:169], v15 offset:32768
    ds_read_b64_tr_b16 a[170:171], v15 offset:33280
    v_mfma_f32_32x32x16_bf16 v[144:159], a[172:175], a[20:23], v[144:159]
    v_cvt_pk_bf16_f32 v163, v38, v39
    ds_read_b64_tr_b16 a[172:173], v16 offset:32768
    ds_read_b64_tr_b16 a[174:175], v16 offset:33280
    s_waitcnt lgkmcnt(8)
    v_mfma_f32_32x32x16_bf16 v[96:111], a[144:147], a[24:27], v[96:111]
    buffer_load_dwordx4 v4, s[12:15], s62 offen offset:3072  lds
    s_add_u32 s63, s51, 0
    buffer_store_dwordx4 v[160:163], v0, s[20:23], s63 offen sc1
    v_max_f32 v40, 0, v40
    ds_read_b64_tr_b16 a[144:145], v15 offset:16384
    ds_read_b64_tr_b16 a[146:147], v15 offset:16896
    v_mfma_f32_32x32x16_bf16 v[112:127], a[148:151], a[24:27], v[112:127]
    v_max_f32 v41, 0, v41
    ds_read_b64_tr_b16 a[148:149], v16 offset:16384
    ds_read_b64_tr_b16 a[150:151], v16 offset:16896
    v_mfma_f32_32x32x16_bf16 v[128:143], a[152:155], a[24:27], v[128:143]
    s_add_u32 m0, s39, 4096
    s_add_u32 s62, s37, 4276352
    buffer_load_dwordx4 v1, s[12:15], s62 offen offset:0  lds
    v_mul_f32 v40, v40, v72
    ds_read_b64_tr_b16 a[152:153], v15 offset:34816
    ds_read_b64_tr_b16 a[154:155], v15 offset:35328
    v_mfma_f32_32x32x16_bf16 v[144:159], a[156:159], a[24:27], v[144:159]
    v_mul_f32 v41, v41, v73
    ds_read_b64_tr_b16 a[156:157], v16 offset:34816
    ds_read_b64_tr_b16 a[158:159], v16 offset:35328
    s_waitcnt lgkmcnt(8)
    v_mfma_f32_32x32x16_bf16 v[96:111], a[160:163], a[28:31], v[96:111]
    s_waitcnt vmcnt(15)
    s_barrier
    buffer_load_dwordx4 v2, s[12:15], s62 offen offset:1024  lds
    v_cvt_pk_bf16_f32 v164, v40, v41
    ds_read_b64_tr_b16 a[160:161], v17 offset:0
    ds_read_b64_tr_b16 a[162:163], v17 offset:512
    v_mfma_f32_32x32x16_bf16 v[112:127], a[164:167], a[28:31], v[112:127]
    v_max_f32 v42, 0, v42
    ds_read_b64_tr_b16 a[164:165], v18 offset:0
    ds_read_b64_tr_b16 a[166:167], v18 offset:512
    v_mfma_f32_32x32x16_bf16 v[128:143], a[168:171], a[28:31], v[128:143]
    buffer_load_dwordx4 v3, s[12:15], s62 offen offset:2048  lds
    v_max_f32 v43, 0, v43
    ds_read_b64_tr_b16 a[168:169], v17 offset:18432
    ds_read_b64_tr_b16 a[170:171], v17 offset:18944
    v_mfma_f32_32x32x16_bf16 v[144:159], a[172:175], a[28:31], v[144:159]
    v_mul_f32 v42, v42, v74
    ds_read_b64_tr_b16 a[172:173], v18 offset:18432
    ds_read_b64_tr_b16 a[174:175], v18 offset:18944
    s_waitcnt lgkmcnt(8)
    v_mfma_f32_32x32x16_bf16 v[96:111], a[144:147], a[32:35], v[96:111]
    buffer_load_dwordx4 v4, s[12:15], s62 offen offset:3072  lds
    v_mul_f32 v43, v43, v75
    ds_read_b64_tr_b16 a[144:145], v17 offset:2048
    ds_read_b64_tr_b16 a[146:147], v17 offset:2560
    v_mfma_f32_32x32x16_bf16 v[112:127], a[148:151], a[32:35], v[112:127]
    v_cvt_pk_bf16_f32 v165, v42, v43
    ds_read_b64_tr_b16 a[148:149], v18 offset:2048
    ds_read_b64_tr_b16 a[150:151], v18 offset:2560
    v_mfma_f32_32x32x16_bf16 v[128:143], a[152:155], a[32:35], v[128:143]
    s_add_u32 m0, s39, 8192
    s_add_u32 s62, s37, 4571264
    buffer_load_dwordx4 v1, s[12:15], s62 offen offset:0  lds
    v_max_f32 v44, 0, v44
    ds_read_b64_tr_b16 a[152:153], v17 offset:20480
    ds_read_b64_tr_b16 a[154:155], v17 offset:20992
    v_mfma_f32_32x32x16_bf16 v[144:159], a[156:159], a[32:35], v[144:159]
    s_barrier
    v_max_f32 v45, 0, v45
    ds_read_b64_tr_b16 a[156:157], v18 offset:20480
    ds_read_b64_tr_b16 a[158:159], v18 offset:20992
    s_waitcnt lgkmcnt(8)
    v_mfma_f32_32x32x16_bf16 v[96:111], a[160:163], a[36:39], v[96:111]
    v_mul_f32 v44, v44, v76
    s_add_u32 m0, s39, 36864
    s_add_u32 s62, s37, 256
    buffer_load_dwordx4 v1, s[12:15], s62 offen offset:0  lds
    ds_read_b64_tr_b16 a[160:161], v17 offset:4096
    ds_read_b64_tr_b16 a[162:163], v17 offset:4608
    v_mfma_f32_32x32x16_bf16 v[112:127], a[164:167], a[36:39], v[112:127]
    v_mul_f32 v45, v45, v77
    ds_read_b64_tr_b16 a[164:165], v18 offset:4096
    ds_read_b64_tr_b16 a[166:167], v18 offset:4608
    v_mfma_f32_32x32x16_bf16 v[128:143], a[168:171], a[36:39], v[128:143]
    v_cvt_pk_bf16_f32 v166, v44, v45
    buffer_load_dwordx4 v2, s[12:15], s62 offen offset:1024  lds
    ds_read_b64_tr_b16 a[168:169], v17 offset:22528
    ds_read_b64_tr_b16 a[170:171], v17 offset:23040
    v_mfma_f32_32x32x16_bf16 v[144:159], a[172:175], a[36:39], v[144:159]
    v_max_f32 v46, 0, v46
    ds_read_b64_tr_b16 a[172:173], v18 offset:22528
    ds_read_b64_tr_b16 a[174:175], v18 offset:23040
    s_waitcnt lgkmcnt(8)
    v_mfma_f32_32x32x16_bf16 v[96:111], a[144:147], a[40:43], v[96:111]
    v_max_f32 v47, 0, v47
    buffer_load_dwordx4 v3, s[12:15], s62 offen offset:2048  lds
    ds_read_b64_tr_b16 a[144:145], v17 offset:6144
    ds_read_b64_tr_b16 a[146:147], v17 offset:6656
    v_mfma_f32_32x32x16_bf16 v[112:127], a[148:151], a[40:43], v[112:127]
    v_mul_f32 v46, v46, v78
    ds_read_b64_tr_b16 a[148:149], v18 offset:6144
    ds_read_b64_tr_b16 a[150:151], v18 offset:6656
    v_mfma_f32_32x32x16_bf16 v[128:143], a[152:155], a[40:43], v[128:143]
    v_mul_f32 v47, v47, v79
    buffer_load_dwordx4 v4, s[12:15], s62 offen offset:3072  lds
    ds_read_b64_tr_b16 a[152:153], v17 offset:24576
    ds_read_b64_tr_b16 a[154:155], v17 offset:25088
    v_mfma_f32_32x32x16_bf16 v[144:159], a[156:159], a[40:43], v[144:159]
    v_cvt_pk_bf16_f32 v167, v46, v47
    ds_read_b64_tr_b16 a[156:157], v18 offset:24576
    ds_read_b64_tr_b16 a[158:159], v18 offset:25088
    s_waitcnt lgkmcnt(8)
    v_mfma_f32_32x32x16_bf16 v[96:111], a[160:163], a[44:47], v[96:111]
    s_add_u32 s63, s51, 1024
    buffer_store_dwordx4 v[164:167], v0, s[20:23], s63 offen sc1
    v_max_f32 v48, 0, v48
    s_add_u32 m0, s39, 40960
    s_add_u32 s62, s37, 295168
    buffer_load_dwordx4 v1, s[12:15], s62 offen offset:0  lds
    ds_read_b64_tr_b16 a[160:161], v17 offset:8192
    ds_read_b64_tr_b16 a[162:163], v17 offset:8704
    v_mfma_f32_32x32x16_bf16 v[112:127], a[164:167], a[44:47], v[112:127]
    v_max_f32 v49, 0, v49
    ds_read_b64_tr_b16 a[164:165], v18 offset:8192
    ds_read_b64_tr_b16 a[166:167], v18 offset:8704
    v_mfma_f32_32x32x16_bf16 v[128:143], a[168:171], a[44:47], v[128:143]
    v_mul_f32 v48, v48, v80
    buffer_load_dwordx4 v2, s[12:15], s62 offen offset:1024  lds
    ds_read_b64_tr_b16 a[168:169], v17 offset:26624
    ds_read_b64_tr_b16 a[170:171], v17 offset:27136
    v_mfma_f32_32x32x16_bf16 v[144:159], a[172:175], a[44:47], v[144:159]
    v_mul_f32 v49, v49, v81
    ds_read_b64_tr_b16 a[172:173], v18 offset:26624
    ds_read_b64_tr_b16 a[174:175], v18 offset:27136
    s_waitcnt lgkmcnt(8)
    v_mfma_f32_32x32x16_bf16 v[96:111], a[144:147], a[48:51], v[96:111]
    v_cvt_pk_bf16_f32 v168, v48, v49
    buffer_load_dwordx4 v3, s[12:15], s62 offen offset:2048  lds
    ds_read_b64_tr_b16 a[144:145], v17 offset:10240
    ds_read_b64_tr_b16 a[146:147], v17 offset:10752
    v_mfma_f32_32x32x16_bf16 v[112:127], a[148:151], a[48:51], v[112:127]
    v_max_f32 v50, 0, v50
    ds_read_b64_tr_b16 a[148:149], v18 offset:10240
    ds_read_b64_tr_b16 a[150:151], v18 offset:10752
    v_mfma_f32_32x32x16_bf16 v[128:143], a[152:155], a[48:51], v[128:143]
    v_max_f32 v51, 0, v51
    buffer_load_dwordx4 v4, s[12:15], s62 offen offset:3072  lds
    ds_read_b64_tr_b16 a[152:153], v17 offset:28672
    ds_read_b64_tr_b16 a[154:155], v17 offset:29184
    v_mfma_f32_32x32x16_bf16 v[144:159], a[156:159], a[48:51], v[144:159]
    v_mul_f32 v50, v50, v82
    ds_read_b64_tr_b16 a[156:157], v18 offset:28672
    ds_read_b64_tr_b16 a[158:159], v18 offset:29184
    s_waitcnt lgkmcnt(8)
    v_mfma_f32_32x32x16_bf16 v[96:111], a[160:163], a[52:55], v[96:111]
    v_mul_f32 v51, v51, v83
    s_add_u32 m0, s39, 45056
    s_add_u32 s62, s37, 590080
    buffer_load_dwordx4 v1, s[12:15], s62 offen offset:0  lds
    ds_read_b64_tr_b16 a[160:161], v17 offset:12288
    ds_read_b64_tr_b16 a[162:163], v17 offset:12800
    v_mfma_f32_32x32x16_bf16 v[112:127], a[164:167], a[52:55], v[112:127]
    v_cvt_pk_bf16_f32 v169, v50, v51
    ds_read_b64_tr_b16 a[164:165], v18 offset:12288
    ds_read_b64_tr_b16 a[166:167], v18 offset:12800
    v_mfma_f32_32x32x16_bf16 v[128:143], a[168:171], a[52:55], v[128:143]
    v_max_f32 v52, 0, v52
    s_add_u32 s64, s79, 1327360
    buffer_load_dword v253, v10, s[12:15], s64 offen
    ds_read_b64_tr_b16 a[168:169], v17 offset:30720
    ds_read_b64_tr_b16 a[170:171], v17 offset:31232
    v_mfma_f32_32x32x16_bf16 v[144:159], a[172:175], a[52:55], v[144:159]
    v_max_f32 v53, 0, v53
    s_add_u32 s64, s79, 2654464
    buffer_load_dword v253, v10, s[12:15], s64 offen
    ds_read_b64_tr_b16 a[172:173], v18 offset:30720
    ds_read_b64_tr_b16 a[174:175], v18 offset:31232
    s_waitcnt lgkmcnt(8)
    v_mfma_f32_32x32x16_bf16 v[96:111], a[144:147], a[56:59], v[96:111]
    v_mul_f32 v52, v52, v84
    ds_read_b64_tr_b16 a[144:145], v17 offset:14336
    ds_read_b64_tr_b16 a[146:147], v17 offset:14848
    v_mfma_f32_32x32x16_bf16 v[112:127], a[148:151], a[56:59], v[112:127]
    v_mul_f32 v53, v53, v85
    ds_read_b64_tr_b16 a[148:149], v18 offset:14336
    ds_read_b64_tr_b16 a[150:151], v18 offset:14848
    v_mfma_f32_32x32x16_bf16 v[128:143], a[152:155], a[56:59], v[128:143]
    v_cvt_pk_bf16_f32 v170, v52, v53
    ds_read_b64_tr_b16 a[152:153], v17 offset:32768
    ds_read_b64_tr_b16 a[154:155], v17 offset:33280
    v_mfma_f32_32x32x16_bf16 v[144:159], a[156:159], a[56:59], v[144:159]
    v_max_f32 v54, 0, v54
    ds_read_b64_tr_b16 a[156:157], v18 offset:32768
    ds_read_b64_tr_b16 a[158:159], v18 offset:33280
    s_waitcnt lgkmcnt(8)
    v_mfma_f32_32x32x16_bf16 v[96:111], a[160:163], a[60:63], v[96:111]
    v_max_f32 v55, 0, v55
    ds_read_b64_tr_b16 a[160:161], v17 offset:16384
    ds_read_b64_tr_b16 a[162:163], v17 offset:16896
    v_mfma_f32_32x32x16_bf16 v[112:127], a[164:167], a[60:63], v[112:127]
    v_mul_f32 v54, v54, v86
    ds_read_b64_tr_b16 a[164:165], v18 offset:16384
    ds_read_b64_tr_b16 a[166:167], v18 offset:16896
    v_mfma_f32_32x32x16_bf16 v[128:143], a[168:171], a[60:63], v[128:143]
    v_mul_f32 v55, v55, v87
    ds_read_b64_tr_b16 a[168:169], v17 offset:34816
    ds_read_b64_tr_b16 a[170:171], v17 offset:35328
    v_mfma_f32_32x32x16_bf16 v[144:159], a[172:175], a[60:63], v[144:159]
    v_cvt_pk_bf16_f32 v171, v54, v55
    ds_read_b64_tr_b16 a[172:173], v18 offset:34816
    ds_read_b64_tr_b16 a[174:175], v18 offset:35328
    s_waitcnt lgkmcnt(8)
    v_mfma_f32_32x32x16_bf16 v[96:111], a[144:147], a[64:67], v[96:111]
    s_waitcnt vmcnt(22)
    s_cbranch_vccnz W0_2
    v_readfirstlane_b32 s72, v248
    s_nop 0
    s_cmp_lg_u32 s72, 0
    s_cbranch_scc0 SLOW0
OK0:
W0_2:
    s_barrier
    s_add_u32 s63, s51, 2048
    buffer_store_dwordx4 v[168:171], v0, s[20:23], s63 offen sc1
    v_max_f32 v56, 0, v56
    ds_read_b64_tr_b16 a[144:145], v19 offset:0
    ds_read_b64_tr_b16 a[146:147], v19 offset:512
    v_mfma_f32_32x32x16_bf16 v[112:127], a[148:151], a[64:67], v[112:127]
    v_max_f32 v57, 0, v57
    ds_read_b64_tr_b16 a[148:149], v20 offset:0
    ds_read_b64_tr_b16 a[150:151], v20 offset:512
    v_mfma_f32_32x32x16_bf16 v[128:143], a[152:155], a[64:67], v[128:143]
    v_mul_f32 v56, v56, v88
    ds_read_b64_tr_b16 a[152:153], v19 offset:18432
    ds_read_b64_tr_b16 a[154:155], v19 offset:18944
    v_mfma_f32_32x32x16_bf16 v[144:159], a[156:159], a[64:67], v[144:159]
    v_mul_f32 v57, v57, v89
    ds_read_b64_tr_b16 a[156:157], v20 offset:18432
    ds_read_b64_tr_b16 a[158:159], v20 offset:18944
    s_waitcnt lgkmcnt(8)
    v_mfma_f32_32x32x16_bf16 v[96:111], a[160:163], a[68:71], v[96:111]
    v_cvt_pk_bf16_f32 v172, v56, v57
    ds_read_b64_tr_b16 a[160:161], v19 offset:2048
    ds_read_b64_tr_b16 a[162:163], v19 offset:2560
    v_mfma_f32_32x32x16_bf16 v[112:127], a[164:167], a[68:71], v[112:127]
    v_max_f32 v58, 0, v58
    ds_read_b64_tr_b16 a[164:165], v20 offset:2048
    ds_read_b64_tr_b16 a[166:167], v20 offset:2560
    v_mfma_f32_32x32x16_bf16 v[128:143], a[168:171], a[68:71], v[128:143]
    v_max_f32 v59, 0, v59
    ds_read_b64_tr_b16 a[168:169], v19 offset:20480
    ds_read_b64_tr_b16 a[170:171], v19 offset:20992
    v_mfma_f32_32x32x16_bf16 v[144:159], a[172:175], a[68:71], v[144:159]
    s_barrier
    v_mul_f32 v58, v58, v90
    ds_read_b64_tr_b16 a[172:173], v20 offset:20480
    ds_read_b64_tr_b16 a[174:175], v20 offset:20992
    s_waitcnt lgkmcnt(8)
    v_mfma_f32_32x32x16_bf16 v[96:111], a[144:147], a[72:75], v[96:111]
    v_mul_f32 v59, v59, v91
    s_add_u32 m0, s39, 73728
    s_add_u32 s62, s37, 1327360
    buffer_load_dwordx4 v1, s[12:15], s62 offen offset:0  lds
    ds_read_b64_tr_b16 a[144:145], v19 offset:4096
    ds_read_b64_tr_b16 a[146:147], v19 offset:4608
    v_mfma_f32_32x32x16_bf16 v[112:127], a[148:151], a[72:75], v[112:127]
    v_cvt_pk_bf16_f32 v173, v58, v59
    ds_read_b64_tr_b16 a[148:149], v20 offset:4096
    ds_read_b64_tr_b16 a[150:151], v20 offset:4608
    v_mfma_f32_32x32x16_bf16 v[128:143], a[152:155], a[72:75], v[128:143]
    v_max_f32 v60, 0, v60
    buffer_load_dwordx4 v2, s[12:15], s62 offen offset:1024  lds
    ds_read_b64_tr_b16 a[152:153], v19 offset:22528
    ds_read_b64_tr_b16 a[154:155], v19 offset:23040
    v_mfma_f32_32x32x16_bf16 v[144:159], a[156:159], a[72:75], v[144:159]
    v_max_f32 v61, 0, v61
    ds_read_b64_tr_b16 a[156:157], v20 offset:22528
    ds_read_b64_tr_b16 a[158:159], v20 offset:23040
    s_waitcnt lgkmcnt(8)
    v_mfma_f32_32x32x16_bf16 v[96:111], a[160:163], a[76:79], v[96:111]
    v_mul_f32 v60, v60, v92
    buffer_load_dwordx4 v3, s[12:15], s62 offen offset:2048  lds
    ds_read_b64_tr_b16 a[160:161], v19 offset:6144
    ds_read_b64_tr_b16 a[162:163], v19 offset:6656
    v_mfma_f32_32x32x16_bf16 v[112:127], a[164:167], a[76:79], v[112:127]
    v_mul_f32 v61, v61, v93
    ds_read_b64_tr_b16 a[164:165], v20 offset:6144
    ds_read_b64_tr_b16 a[166:167], v20 offset:6656
    v_mfma_f32_32x32x16_bf16 v[128:143], a[168:171], a[76:79], v[128:143]
    v_cvt_pk_bf16_f32 v174, v60, v61
    buffer_load_dwordx4 v4, s[12:15], s62 offen offset:3072  lds
    ds_read_b64_tr_b16 a[168:169], v19 offset:24576
    ds_read_b64_tr_b16 a[170:171], v19 offset:25088
    v_mfma_f32_32x32x16_bf16 v[144:159], a[172:175], a[76:79], v[144:159]
    v_max_f32 v62, 0, v62
    ds_read_b64_tr_b16 a[172:173], v20 offset:24576
    ds_read_b64_tr_b16 a[174:175], v20 offset:25088
    s_waitcnt lgkmcnt(8)
    v_mfma_f32_32x32x16_bf16 v[96:111], a[144:147], a[80:83], v[96:111]
    v_max_f32 v63, 0, v63
    s_add_u32 m0, s39, 77824
    s_add_u32 s62, s37, 1622272
    buffer_load_dwordx4 v1, s[12:15], s62 offen offset:0  lds
    ds_read_b64_tr_b16 a[144:145], v19 offset:8192
    ds_read_b64_tr_b16 a[146:147], v19 offset:8704
    v_mfma_f32_32x32x16_bf16 v[112:127], a[148:151], a[80:83], v[112:127]
    v_mul_f32 v62, v62, v94
    ds_read_b64_tr_b16 a[148:149], v20 offset:8192
    ds_read_b64_tr_b16 a[150:151], v20 offset:8704
    v_mfma_f32_32x32x16_bf16 v[128:143], a[152:155], a[80:83], v[128:143]
    v_mul_f32 v63, v63, v95
    buffer_load_dwordx4 v2, s[12:15], s62 offen offset:1024  lds
    ds_read_b64_tr_b16 a[152:153], v19 offset:26624
    ds_read_b64_tr_b16 a[154:155], v19 offset:27136
    v_mfma_f32_32x32x16_bf16 v[144:159], a[156:159], a[80:83], v[144:159]
    v_cvt_pk_bf16_f32 v175, v62, v63
    ds_read_b64_tr_b16 a[156:157], v20 offset:26624
    ds_read_b64_tr_b16 a[158:159], v20 offset:27136
    s_waitcnt lgkmcnt(8)
    v_mfma_f32_32x32x16_bf16 v[96:111], a[160:163], a[84:87], v[96:111]
    s_add_u32 s63, s51, 3072
    buffer_store_dwordx4 v[172:175], v0, s[20:23], s63 offen sc1
    buffer_load_dwordx4 v3, s[12:15], s62 offen offset:2048  lds
    ds_read_b64_tr_b16 a[160:161], v19 offset:10240
    ds_read_b64_tr_b16 a[162:163], v19 offset:10752
    v_mfma_f32_32x32x16_bf16 v[112:127], a[164:167], a[84:87], v[112:127]
    ds_read_b64_tr_b16 a[164:165], v20 offset:10240
    ds_read_b64_tr_b16 a[166:167], v20 offset:10752
    v_mfma_f32_32x32x16_bf16 v[128:143], a[168:171], a[84:87], v[128:143]
    buffer_load_dwordx4 v4, s[12:15], s62 offen offset:3072  lds
    ds_read_b64_tr_b16 a[168:169], v19 offset:28672
    ds_read_b64_tr_b16 a[170:171], v19 offset:29184
    v_mfma_f32_32x32x16_bf16 v[144:159], a[172:175], a[84:87], v[144:159]
    ds_read_b64_tr_b16 a[172:173], v20 offset:28672
    ds_read_b64_tr_b16 a[174:175], v20 offset:29184
    s_waitcnt lgkmcnt(8)
    v_mfma_f32_32x32x16_bf16 v[96:111], a[144:147], a[88:91], v[96:111]
    s_add_u32 m0, s39, 81920
    s_add_u32 s62, s37, 1917184
    buffer_load_dwordx4 v1, s[12:15], s62 offen offset:0  lds
    ds_read_b64_tr_b16 a[144:145], v19 offset:12288
    ds_read_b64_tr_b16 a[146:147], v19 offset:12800
    v_mfma_f32_32x32x16_bf16 v[112:127], a[148:151], a[88:91], v[112:127]
    ds_read_b64_tr_b16 a[148:149], v20 offset:12288
    ds_read_b64_tr_b16 a[150:151], v20 offset:12800
    v_mfma_f32_32x32x16_bf16 v[128:143], a[152:155], a[88:91], v[128:143]
    s_add_u32 s64, s79, 3981568
    buffer_load_dword v253, v10, s[12:15], s64 offen
    ds_read_b64_tr_b16 a[152:153], v19 offset:30720
    ds_read_b64_tr_b16 a[154:155], v19 offset:31232
    v_mfma_f32_32x32x16_bf16 v[144:159], a[156:159], a[88:91], v[144:159]
    s_add_u32 s64, s79, 384
    buffer_load_dword v253, v10, s[12:15], s64 offen
    ds_read_b64_tr_b16 a[156:157], v20 offset:30720
    ds_read_b64_tr_b16 a[158:159], v20 offset:31232
    s_waitcnt lgkmcnt(8)
    v_mfma_f32_32x32x16_bf16 v[96:111], a[160:163], a[92:95], v[96:111]
    ds_read_b64_tr_b16 a[160:161], v19 offset:14336
    ds_read_b64_tr_b16 a[162:163], v19 offset:14848
    v_mfma_f32_32x32x16_bf16 v[112:127], a[164:167], a[92:95], v[112:127]
    ds_read_b64_tr_b16 a[164:165], v20 offset:14336
    ds_read_b64_tr_b16 a[166:167], v20 offset:14848
    v_mfma_f32_32x32x16_bf16 v[128:143], a[168:171], a[92:95], v[128:143]
    ds_read_b64_tr_b16 a[168:169], v19 offset:32768
    ds_read_b64_tr_b16 a[170:171], v19 offset:33280
    v_mfma_f32_32x32x16_bf16 v[144:159], a[172:175], a[92:95], v[144:159]
    ds_read_b64_tr_b16 a[172:173], v20 offset:32768
    ds_read_b64_tr_b16 a[174:175], v20 offset:33280
    s_waitcnt lgkmcnt(8)
    v_mfma_f32_32x32x16_bf16 v[96:111], a[144:147], a[96:99], v[96:111]
    ds_read_b64_tr_b16 a[144:145], v19 offset:16384
    ds_read_b64_tr_b16 a[146:147], v19 offset:16896
    v_mfma_f32_32x32x16_bf16 v[112:127], a[148:151], a[96:99], v[112:127]
    ds_read_b64_tr_b16 a[148:149], v20 offset:16384
    ds_read_b64_tr_b16 a[150:151], v20 offset:16896
    v_mfma_f32_32x32x16_bf16 v[128:143], a[152:155], a[96:99], v[128:143]
    ds_read_b64_tr_b16 a[152:153], v19 offset:34816
    ds_read_b64_tr_b16 a[154:155], v19 offset:35328
    v_mfma_f32_32x32x16_bf16 v[144:159], a[156:159], a[96:99], v[144:159]
    ds_read_b64_tr_b16 a[156:157], v20 offset:34816
    ds_read_b64_tr_b16 a[158:159], v20 offset:35328
    s_waitcnt lgkmcnt(8)
    v_mfma_f32_32x32x16_bf16 v[96:111], a[160:163], a[100:103], v[96:111]
    s_waitcnt vmcnt(25)
    s_barrier
    ds_read_b64_tr_b16 a[160:161], v13 offset:0
    ds_read_b64_tr_b16 a[162:163], v13 offset:512
    v_mfma_f32_32x32x16_bf16 v[112:127], a[164:167], a[100:103], v[112:127]
    ds_read_b64_tr_b16 a[164:165], v14 offset:0
    ds_read_b64_tr_b16 a[166:167], v14 offset:512
    v_mfma_f32_32x32x16_bf16 v[128:143], a[168:171], a[100:103], v[128:143]
    ds_read_b64_tr_b16 a[168:169], v13 offset:18432
    ds_read_b64_tr_b16 a[170:171], v13 offset:18944
    v_mfma_f32_32x32x16_bf16 v[144:159], a[172:175], a[100:103], v[144:159]
    ds_read_b64_tr_b16 a[172:173], v14 offset:18432
    ds_read_b64_tr_b16 a[174:175], v14 offset:18944
    s_waitcnt lgkmcnt(8)
    v_mfma_f32_32x32x16_bf16 v[96:111], a[144:147], a[104:107], v[96:111]
    ds_read_b64_tr_b16 a[144:145], v13 offset:2048
    ds_read_b64_tr_b16 a[146:147], v13 offset:2560
    v_mfma_f32_32x32x16_bf16 v[112:127], a[148:151], a[104:107], v[112:127]
    ds_read_b64_tr_b16 a[148:149], v14 offset:2048
    ds_read_b64_tr_b16 a[150:151], v14 offset:2560
    v_mfma_f32_32x32x16_bf16 v[128:143], a[152:155], a[104:107], v[128:143]
    ds_read_b64_tr_b16 a[152:153], v13 offset:20480
    ds_read_b64_tr_b16 a[154:155], v13 offset:20992
    v_mfma_f32_32x32x16_bf16 v[144:159], a[156:159], a[104:107], v[144:159]
    s_barrier
    ds_read_b64_tr_b16 a[156:157], v14 offset:20480
    ds_read_b64_tr_b16 a[158:159], v14 offset:20992
    s_waitcnt lgkmcnt(8)
    v_mfma_f32_32x32x16_bf16 v[96:111], a[160:163], a[108:111], v[96:111]
    s_add_u32 m0, s39, 110592
    s_add_u32 s62, s37, 2654464
    buffer_load_dwordx4 v1, s[12:15], s62 offen offset:0  lds
    ds_read_b64_tr_b16 a[160:161], v13 offset:4096
    ds_read_b64_tr_b16 a[162:163], v13 offset:4608
    v_mfma_f32_32x32x16_bf16 v[112:127], a[164:167], a[108:111], v[112:127]
    ds_read_b64_tr_b16 a[164:165], v14 offset:4096
    ds_read_b64_tr_b16 a[166:167], v14 offset:4608
    v_mfma_f32_32x32x16_bf16 v[128:143], a[168:171], a[108:111], v[128:143]
    buffer_load_dwordx4 v2, s[12:15], s62 offen offset:1024  lds
    ds_read_b64_tr_b16 a[168:169], v13 offset:22528
    ds_read_b64_tr_b16 a[170:171], v13 offset:23040
    v_mfma_f32_32x32x16_bf16 v[144:159], a[172:175], a[108:111], v[144:159]
    ds_read_b64_tr_b16 a[172:173], v14 offset:22528
    ds_read_b64_tr_b16 a[174:175], v14 offset:23040
    s_waitcnt lgkmcnt(8)
    v_mfma_f32_32x32x16_bf16 v[96:111], a[144:147], a[112:115], v[96:111]
    buffer_load_dwordx4 v3, s[12:15], s62 offen offset:2048  lds
    ds_read_b64_tr_b16 a[144:145], v13 offset:6144
    ds_read_b64_tr_b16 a[146:147], v13 offset:6656
    v_mfma_f32_32x32x16_bf16 v[112:127], a[148:151], a[112:115], v[112:127]
    ds_read_b64_tr_b16 a[148:149], v14 offset:6144
    ds_read_b64_tr_b16 a[150:151], v14 offset:6656
    v_mfma_f32_32x32x16_bf16 v[128:143], a[152:155], a[112:115], v[128:143]
    buffer_load_dwordx4 v4, s[12:15], s62 offen offset:3072  lds
    ds_read_b64_tr_b16 a[152:153], v13 offset:24576
    ds_read_b64_tr_b16 a[154:155], v13 offset:25088
    v_mfma_f32_32x32x16_bf16 v[144:159], a[156:159], a[112:115], v[144:159]
    ds_read_b64_tr_b16 a[156:157], v14 offset:24576
    ds_read_b64_tr_b16 a[158:159], v14 offset:25088
    s_waitcnt lgkmcnt(8)
    v_mfma_f32_32x32x16_bf16 v[96:111], a[160:163], a[116:119], v[96:111]
    s_add_u32 m0, s39, 114688
    s_add_u32 s62, s37, 2949376
    buffer_load_dwordx4 v1, s[12:15], s62 offen offset:0  lds
    ds_read_b64_tr_b16 a[160:161], v13 offset:8192
    ds_read_b64_tr_b16 a[162:163], v13 offset:8704
    v_mfma_f32_32x32x16_bf16 v[112:127], a[164:167], a[116:119], v[112:127]
    ds_read_b64_tr_b16 a[164:165], v14 offset:8192
    ds_read_b64_tr_b16 a[166:167], v14 offset:8704
    v_mfma_f32_32x32x16_bf16 v[128:143], a[168:171], a[116:119], v[128:143]
    buffer_load_dwordx4 v2, s[12:15], s62 offen offset:1024  lds
    ds_read_b64_tr_b16 a[168:169], v13 offset:26624
    ds_read_b64_tr_b16 a[170:171], v13 offset:27136
    v_mfma_f32_32x32x16_bf16 v[144:159], a[172:175], a[116:119], v[144:159]
    ds_read_b64_tr_b16 a[172:173], v14 offset:26624
    ds_read_b64_tr_b16 a[174:175], v14 offset:27136
    s_waitcnt lgkmcnt(8)
    v_mfma_f32_32x32x16_bf16 v[96:111], a[144:147], a[120:123], v[96:111]
    buffer_load_dwordx4 v3, s[12:15], s62 offen offset:2048  lds
    ds_read_b64_tr_b16 a[144:145], v13 offset:10240
    ds_read_b64_tr_b16 a[146:147], v13 offset:10752
    v_mfma_f32_32x32x16_bf16 v[112:127], a[148:151], a[120:123], v[112:127]
    ds_read_b64_tr_b16 a[148:149], v14 offset:10240
    ds_read_b64_tr_b16 a[150:151], v14 offset:10752
    v_mfma_f32_32x32x16_bf16 v[128:143], a[152:155], a[120:123], v[128:143]
    buffer_load_dwordx4 v4, s[12:15], s62 offen offset:3072  lds
    ds_read_b64_tr_b16 a[152:153], v13 offset:28672
    ds_read_b64_tr_b16 a[154:155], v13 offset:29184
    v_mfma_f32_32x32x16_bf16 v[144:159], a[156:159], a[120:123], v[144:159]
    ds_read_b64_tr_b16 a[156:157], v14 offset:28672
    ds_read_b64_tr_b16 a[158:159], v14 offset:29184
    s_waitcnt lgkmcnt(8)
    v_mfma_f32_32x32x16_bf16 v[96:111], a[160:163], a[124:127], v[96:111]
    s_add_u32 m0, s39, 118784
    s_add_u32 s62, s37, 3244288
    buffer_load_dwordx4 v1, s[12:15], s62 offen offset:0  lds
    ds_read_b64_tr_b16 a[160:161], v13 offset:12288
    ds_read_b64_tr_b16 a[162:163], v13 offset:12800
    v_mfma_f32_32x32x16_bf16 v[112:127], a[164:167], a[124:127], v[112:127]
    ds_read_b64_tr_b16 a[164:165], v14 offset:12288
    ds_read_b64_tr_b16 a[166:167], v14 offset:12800
    v_mfma_f32_32x32x16_bf16 v[128:143], a[168:171], a[124:127], v[128:143]
    s_add_u32 s64, s79, 1327488
    buffer_load_dword v253, v10, s[12:15], s64 offen
    ds_read_b64_tr_b16 a[168:169], v13 offset:30720
    ds_read_b64_tr_b16 a[170:171], v13 offset:31232
    v_mfma_f32_32x32x16_bf16 v[144:159], a[172:175], a[124:127], v[144:159]
    s_add_u32 s64, s79, 2654592
    buffer_load_dword v253, v10, s[12:15], s64 offen
    ds_read_b64_tr_b16 a[172:173], v14 offset:30720
    ds_read_b64_tr_b16 a[174:175], v14 offset:31232
    s_waitcnt lgkmcnt(8)
    v_mfma_f32_32x32x16_bf16 v[96:111], a[144:147], a[128:131], v[96:111]
    ds_read_b64_tr_b16 a[144:145], v13 offset:14336
    ds_read_b64_tr_b16 a[146:147], v13 offset:14848
    v_mfma_f32_32x32x16_bf16 v[112:127], a[148:151], a[128:131], v[112:127]
    ds_read_b64_tr_b16 a[148:149], v14 offset:14336
    ds_read_b64_tr_b16 a[150:151], v14 offset:14848
    v_mfma_f32_32x32x16_bf16 v[128:143], a[152:155], a[128:131], v[128:143]
    ds_read_b64_tr_b16 a[152:153], v13 offset:32768
    ds_read_b64_tr_b16 a[154:155], v13 offset:33280
    v_mfma_f32_32x32x16_bf16 v[144:159], a[156:159], a[128:131], v[144:159]
    ds_read_b64_tr_b16 a[156:157], v14 offset:32768
    ds_read_b64_tr_b16 a[158:159], v14 offset:33280
    s_waitcnt lgkmcnt(8)
    v_mfma_f32_32x32x16_bf16 v[96:111], a[160:163], a[132:135], v[96:111]
    ds_read_b64_tr_b16 a[160:161], v13 offset:16384
    ds_read_b64_tr_b16 a[162:163], v13 offset:16896
    v_mfma_f32_32x32x16_bf16 v[112:127], a[164:167], a[132:135], v[112:127]
    ds_read_b64_tr_b16 a[164:165], v14 offset:16384
    ds_read_b64_tr_b16 a[166:167], v14 offset:16896
    v_mfma_f32_32x32x16_bf16 v[128:143], a[168:171], a[132:135], v[128:143]
    ds_read_b64_tr_b16 a[168:169], v13 offset:34816
    ds_read_b64_tr_b16 a[170:171], v13 offset:35328
    v_mfma_f32_32x32x16_bf16 v[144:159], a[172:175], a[132:135], v[144:159]
    ds_read_b64_tr_b16 a[172:173], v14 offset:34816
    ds_read_b64_tr_b16 a[174:175], v14 offset:35328
    s_waitcnt lgkmcnt(8)
    v_mfma_f32_32x32x16_bf16 v[96:111], a[144:147], a[136:139], v[96:111]
    s_waitcnt vmcnt(26)
    s_waitcnt vmcnt(16)
    s_barrier
    s_cbranch_vccnz W0_3
    s_add_u32 s78, s72, 1
    v_mov_b32 v252, s78
    buffer_store_dword v252, off, s[20:23], s76 sc1
W0_3:
    ds_read_b64_tr_b16 a[144:145], v15 offset:0
    ds_read_b64_tr_b16 a[146:147], v15 offset:512
    v_mfma_f32_32x32x16_bf16 v[112:127], a[148:151], a[136:139], v[112:127]
    ds_read_b64_tr_b16 a[148:149], v16 offset:0
    ds_read_b64_tr_b16 a[150:151], v16 offset:512
    v_mfma_f32_32x32x16_bf16 v[128:143], a[152:155], a[136:139], v[128:143]
    ds_read_b64_tr_b16 a[152:153], v15 offset:18432
    ds_read_b64_tr_b16 a[154:155], v15 offset:18944
    v_mfma_f32_32x32x16_bf16 v[144:159], a[156:159], a[136:139], v[144:159]
    ds_read_b64_tr_b16 a[156:157], v16 offset:18432
    ds_read_b64_tr_b16 a[158:159], v16 offset:18944
    s_waitcnt lgkmcnt(8)
    v_mfma_f32_32x32x16_bf16 v[96:111], a[160:163], a[140:143], v[96:111]
    ds_read_b64_tr_b16 a[160:161], v15 offset:2048
    ds_read_b64_tr_b16 a[162:163], v15 offset:2560
    v_mfma_f32_32x32x16_bf16 v[112:127], a[164:167], a[140:143], v[112:127]
    ds_read_b64_tr_b16 a[164:165], v16 offset:2048
    ds_read_b64_tr_b16 a[166:167], v16 offset:2560
    v_mfma_f32_32x32x16_bf16 v[128:143], a[168:171], a[140:143], v[128:143]
    ds_read_b64_tr_b16 a[168:169], v15 offset:20480
    ds_read_b64_tr_b16 a[170:171], v15 offset:20992
    v_mfma_f32_32x32x16_bf16 v[144:159], a[172:175], a[140:143], v[144:159]
    s_barrier
    ds_read_b64_tr_b16 a[172:173], v16 offset:20480
    ds_read_b64_tr_b16 a[174:175], v16 offset:20992
    s_waitcnt lgkmcnt(8)
    v_mfma_f32_32x32x16_bf16 v[32:47], a[144:147], a[0:3], 0
    s_add_u32 m0, s39, 0
    s_add_u32 s62, s37, 3981568
    buffer_load_dwordx4 v1, s[12:15], s62 offen offset:0  lds
    ds_read_b64_tr_b16 a[144:145], v15 offset:4096
    ds_read_b64_tr_b16 a[146:147], v15 offset:4608
    v_mfma_f32_32x32x16_bf16 v[48:63], a[148:151], a[0:3], 0
    ds_read_b64_tr_b16 a[148:149], v16 offset:4096
    ds_read_b64_tr_b16 a[150:151], v16 offset:4608
    v_mfma_f32_32x32x16_bf16 v[64:79], a[152:155], a[0:3], 0
    buffer_load_dwordx4 v2, s[12:15], s62 offen offset:1024  lds
    ds_read_b64_tr_b16 a[152:153], v15 offset:22528
    ds_read_b64_tr_b16 a[154:155], v15 offset:23040
    v_mfma_f32_32x32x16_bf16 v[80:95], a[156:159], a[0:3], 0
    ds_read_b64_tr_b16 a[156:157], v16 offset:22528
    ds_read_b64_tr_b16 a[158:159], v16 offset:23040
    s_waitcnt lgkmcnt(8)
    v_mfma_f32_32x32x16_bf16 v[32:47], a[160:163], a[4:7], v[32:47]
    v_max_f32 v96, 0, v96
    buffer_load_dwordx4 v3, s[12:15], s62 offen offset:2048  lds
    ds_read_b64_tr_b16 a[160:161], v15 offset:6144
    ds_read_b64_tr_b16 a[162:163], v15 offset:6656
    v_mfma_f32_32x32x16_bf16 v[48:63], a[164:167], a[4:7], v[48:63]
    v_max_f32 v97, 0, v97
    ds_read_b64_tr_b16 a[164:165], v16 offset:6144
    ds_read_b64_tr_b16 a[166:167], v16 offset:6656
    v_mfma_f32_32x32x16_bf16 v[64:79], a[168:171], a[4:7], v[64:79]
    v_mul_f32 v96, v96, v128
    buffer_load_dwordx4 v4, s[12:15], s62 offen offset:3072  lds
    ds_read_b64_tr_b16 a[168:169], v15 offset:24576
    ds_read_b64_tr_b16 a[170:171], v15 offset:25088
    v_mfma_f32_32x32x16_bf16 v[80:95], a[172:175], a[4:7], v[80:95]
    v_mul_f32 v97, v97, v129
    ds_read_b64_tr_b16 a[172:173], v16 offset:24576
    ds_read_b64_tr_b16 a[174:175], v16 offset:25088
    s_waitcnt lgkmcnt(8)
    v_mfma_f32_32x32x16_bf16 v[32:47], a[144:147], a[8:11], v[32:47]
    v_cvt_pk_bf16_f32 v176, v96, v97
    s_add_u32 m0, s39, 4096
    s_add_u32 s62, s37, 4276480
    buffer_load_dwordx4 v1, s[12:15], s62 offen offset:0  lds
    ds_read_b64_tr_b16 a[144:145], v15 offset:8192
    ds_read_b64_tr_b16 a[146:147], v15 offset:8704
    v_mfma_f32_32x32x16_bf16 v[48:63], a[148:151], a[8:11], v[48:63]
    v_max_f32 v98, 0, v98
    ds_read_b64_tr_b16 a[148:149], v16 offset:8192
    ds_read_b64_tr_b16 a[150:151], v16 offset:8704
    v_mfma_f32_32x32x16_bf16 v[64:79], a[152:155], a[8:11], v[64:79]
    v_max_f32 v99, 0, v99
    buffer_load_dwordx4 v2, s[12:15], s62 offen offset:1024  lds
    ds_read_b64_tr_b16 a[152:153], v15 offset:26624
    ds_read_b64_tr_b16 a[154:155], v15 offset:27136
    v_mfma_f32_32x32x16_bf16 v[80:95], a[156:159], a[8:11], v[80:95]
    v_mul_f32 v98, v98, v130
    ds_read_b64_tr_b16 a[156:157], v16 offset:26624
    ds_read_b64_tr_b16 a[158:159], v16 offset:27136
    s_waitcnt lgkmcnt(8)
    v_mfma_f32_32x32x16_bf16 v[32:47], a[160:163], a[12:15], v[32:47]
    v_mul_f32 v99, v99, v131
    buffer_load_dwordx4 v3, s[12:15], s62 offen offset:2048  lds
    ds_read_b64_tr_b16 a[160:161], v15 offset:10240
    ds_read_b64_tr_b16 a[162:163], v15 offset:10752
    v_mfma_f32_32x32x16_bf16 v[48:63], a[164:167], a[12:15], v[48:63]
    v_cvt_pk_bf16_f32 v177, v98, v99
    ds_read_b64_tr_b16 a[164:165], v16 offset:10240
    ds_read_b64_tr_b16 a[166:167], v16 offset:10752
    v_mfma_f32_32x32x16_bf16 v[64:79], a[168:171], a[12:15], v[64:79]
    v_max_f32 v100, 0, v100
    buffer_load_dwordx4 v4, s[12:15], s62 offen offset:3072  lds
    ds_read_b64_tr_b16 a[168:169], v15 offset:28672
    ds_read_b64_tr_b16 a[170:171], v15 offset:29184
    v_mfma_f32_32x32x16_bf16 v[80:95], a[172:175], a[12:15], v[80:95]
    v_max_f32 v101, 0, v101
    ds_read_b64_tr_b16 a[172:173], v16 offset:28672
    ds_read_b64_tr_b16 a[174:175], v16 offset:29184
    s_waitcnt lgkmcnt(8)
    v_mfma_f32_32x32x16_bf16 v[32:47], a[144:147], a[16:19], v[32:47]
    v_mul_f32 v100, v100, v132
    s_add_u32 m0, s39, 8192
    s_add_u32 s62, s37, 4571392
    buffer_load_dwordx4 v1, s[12:15], s62 offen offset:0  lds
    ds_read_b64_tr_b16 a[144:145], v15 offset:12288
    ds_read_b64_tr_b16 a[146:147], v15 offset:12800
    v_mfma_f32_32x32x16_bf16 v[48:63], a[148:151], a[16:19], v[48:63]
    v_mul_f32 v101, v101, v133
    ds_read_b64_tr_b16 a[148:149], v16 offset:12288
    ds_read_b64_tr_b16 a[150:151], v16 offset:12800
    v_mfma_f32_32x32x16_bf16 v[64:79], a[152:155], a[16:19], v[64:79]
    v_cvt_pk_bf16_f32 v178, v100, v101
    s_add_u32 s64, s79, 3981696
    buffer_load_dword v253, v10, s[12:15], s64 offen
    ds_read_b64_tr_b16 a[152:153], v15 offset:30720
    ds_read_b64_tr_b16 a[154:155], v15 offset:31232
    v_mfma_f32_32x32x16_bf16 v[80:95], a[156:159], a[16:19], v[80:95]
    v_max_f32 v102, 0, v102
    s_add_u32 s64, s80, 0
    buffer_load_dword v253, v10, s[12:15], s64 offen
    ds_read_b64_tr_b16 a[156:157], v16 offset:30720
    ds_read_b64_tr_b16 a[158:159], v16 offset:31232
    s_waitcnt lgkmcnt(8)
    v_mfma_f32_32x32x16_bf16 v[32:47], a[160:163], a[20:23], v[32:47]
    v_max_f32 v103, 0, v103
    ds_read_b64_tr_b16 a[160:161], v15 offset:14336
    ds_read_b64_tr_b16 a[162:163], v15 offset:14848
    v_mfma_f32_32x32x16_bf16 v[48:63], a[164:167], a[20:23], v[48:63]
    v_mul_f32 v102, v102, v134
    ds_read_b64_tr_b16 a[164:165], v16 offset:14336
    ds_read_b64_tr_b16 a[166:167], v16 offset:14848
    v_mfma_f32_32x32x16_bf16 v[64:79], a[168:171], a[20:23], v[64:79]
    v_mul_f32 v103, v103, v135
    ds_read_b64_tr_b16 a[168:169], v15 offset:32768
    ds_read_b64_tr_b16 a[170:171], v15 offset:33280
    v_mfma_f32_32x32x16_bf16 v[80:95], a[172:175], a[20:23], v[80:95]
    v_cvt_pk_bf16_f32 v179, v102, v103
    ds_read_b64_tr_b16 a[172:173], v16 offset:32768
    ds_read_b64_tr_b16 a[174:175], v16 offset:33280
    s_waitcnt lgkmcnt(8)
    v_mfma_f32_32x32x16_bf16 v[32:47], a[144:147], a[24:27], v[32:47]
    s_add_u32 s63, s51, 4096
    buffer_store_dwordx4 v[176:179], v0, s[20:23], s63 offen sc1
    v_max_f32 v104, 0, v104
    ds_read_b64_tr_b16 a[144:145], v15 offset:16384
    ds_read_b64_tr_b16 a[146:147], v15 offset:16896
    v_mfma_f32_32x32x16_bf16 v[48:63], a[148:151], a[24:27], v[48:63]
    v_max_f32 v105, 0, v105
    ds_read_b64_tr_b16 a[148:149], v16 offset:16384
    ds_read_b64_tr_b16 a[150:151], v16 offset:16896
    v_mfma_f32_32x32x16_bf16 v[64:79], a[152:155], a[24:27], v[64:79]
    v_mul_f32 v104, v104, v136
    ds_read_b64_tr_b16 a[152:153], v15 offset:34816
    ds_read_b64_tr_b16 a[154:155], v15 offset:35328
    v_mfma_f32_32x32x16_bf16 v[80:95], a[156:159], a[24:27], v[80:95]
    v_mul_f32 v105, v105, v137
    ds_read_b64_tr_b16 a[156:157], v16 offset:34816
    ds_read_b64_tr_b16 a[158:159], v16 offset:35328
    s_waitcnt lgkmcnt(8)
    v_mfma_f32_32x32x16_bf16 v[32:47], a[160:163], a[28:31], v[32:47]
    s_waitcnt vmcnt(25)
    s_barrier
    v_cvt_pk_bf16_f32 v180, v104, v105
    ds_read_b64_tr_b16 a[160:161], v17 offset:0
    ds_read_b64_tr_b16 a[162:163], v17 offset:512
    v_mfma_f32_32x32x16_bf16 v[48:63], a[164:167], a[28:31], v[48:63]
    v_max_f32 v106, 0, v106
    ds_read_b64_tr_b16 a[164:165], v18 offset:0
    ds_read_b64_tr_b16 a[166:167], v18 offset:512
    v_mfma_f32_32x32x16_bf16 v[64:79], a[168:171], a[28:31], v[64:79]
    v_max_f32 v107, 0, v107
    ds_read_b64_tr_b16 a[168:169], v17 offset:18432
    ds_read_b64_tr_b16 a[170:171], v17 offset:18944
    v_mfma_f32_32x32x16_bf16 v[80:95], a[172:175], a[28:31], v[80:95]
    v_mul_f32 v106, v106, v138
    ds_read_b64_tr_b16 a[172:173], v18 offset:18432
    ds_read_b64_tr_b16 a[174:175], v18 offset:18944
    s_waitcnt lgkmcnt(8)
    v_mfma_f32_32x32x16_bf16 v[32:47], a[144:147], a[32:35], v[32:47]
    v_mul_f32 v107, v107, v139
    ds_read_b64_tr_b16 a[144:145], v17 offset:2048
    ds_read_b64_tr_b16 a[146:147], v17 offset:2560
    v_mfma_f32_32x32x16_bf16 v[48:63], a[148:151], a[32:35], v[48:63]
    v_cvt_pk_bf16_f32 v181, v106, v107
    ds_read_b64_tr_b16 a[148:149], v18 offset:2048
    ds_read_b64_tr_b16 a[150:151], v18 offset:2560
    v_mfma_f32_32x32x16_bf16 v[64:79], a[152:155], a[32:35], v[64:79]
    v_max_f32 v108, 0, v108
    ds_read_b64_tr_b16 a[152:153], v17 offset:20480
    ds_read_b64_tr_b16 a[154:155], v17 offset:20992
    v_mfma_f32_32x32x16_bf16 v[80:95], a[156:159], a[32:35], v[80:95]
    s_barrier
    v_max_f32 v109, 0, v109
    ds_read_b64_tr_b16 a[156:157], v18 offset:20480
    ds_read_b64_tr_b16 a[158:159], v18 offset:20992
    s_waitcnt lgkmcnt(8)
    v_mfma_f32_32x32x16_bf16 v[32:47], a[160:163], a[36:39], v[32:47]
    v_mul_f32 v108, v108, v140
    s_add_u32 m0, s39, 36864
    s_add_u32 s62, s37, 384
    buffer_load_dwordx4 v1, s[12:15], s62 offen offset:0  lds
    ds_read_b64_tr_b16 a[160:161], v17 offset:4096
    ds_read_b64_tr_b16 a[162:163], v17 offset:4608
    v_mfma_f32_32x32x16_bf16 v[48:63], a[164:167], a[36:39], v[48:63]
    v_mul_f32 v109, v109, v141
    ds_read_b64_tr_b16 a[164:165], v18 offset:4096
    ds_read_b64_tr_b16 a[166:167], v18 offset:4608
    v_mfma_f32_32x32x16_bf16 v[64:79], a[168:171], a[36:39], v[64:79]
    v_cvt_pk_bf16_f32 v182, v108, v109
    buffer_load_dwordx4 v2, s[12:15], s62 offen offset:1024  lds
    ds_read_b64_tr_b16 a[168:169], v17 offset:22528
    ds_read_b64_tr_b16 a[170:171], v17 offset:23040
    v_mfma_f32_32x32x16_bf16 v[80:95], a[172:175], a[36:39], v[80:95]
    v_max_f32 v110, 0, v110
    ds_read_b64_tr_b16 a[172:173], v18 offset:22528
    ds_read_b64_tr_b16 a[174:175], v18 offset:23040
    s_waitcnt lgkmcnt(8)
    v_mfma_f32_32x32x16_bf16 v[32:47], a[144:147], a[40:43], v[32:47]
    v_max_f32 v111, 0, v111
    buffer_load_dwordx4 v3, s[12:15], s62 offen offset:2048  lds
    ds_read_b64_tr_b16 a[144:145], v17 offset:6144
    ds_read_b64_tr_b16 a[146:147], v17 offset:6656
    v_mfma_f32_32x32x16_bf16 v[48:63], a[148:151], a[40:43], v[48:63]
    v_mul_f32 v110, v110, v142
    ds_read_b64_tr_b16 a[148:149], v18 offset:6144
    ds_read_b64_tr_b16 a[150:151], v18 offset:6656
    v_mfma_f32_32x32x16_bf16 v[64:79], a[152:155], a[40:43], v[64:79]
    v_mul_f32 v111, v111, v143
    buffer_load_dwordx4 v4, s[12:15], s62 offen offset:3072  lds
    ds_read_b64_tr_b16 a[152:153], v17 offset:24576
    ds_read_b64_tr_b16 a[154:155], v17 offset:25088
    v_mfma_f32_32x32x16_bf16 v[80:95], a[156:159], a[40:43], v[80:95]
    v_cvt_pk_bf16_f32 v183, v110, v111
    ds_read_b64_tr_b16 a[156:157], v18 offset:24576
    ds_read_b64_tr_b16 a[158:159], v18 offset:25088
    s_waitcnt lgkmcnt(8)
    v_mfma_f32_32x32x16_bf16 v[32:47], a[160:163], a[44:47], v[32:47]
    s_add_u32 s63, s51, 5120
    buffer_store_dwordx4 v[180:183], v0, s[20:23], s63 offen sc1
    v_max_f32 v112, 0, v112
    s_add_u32 m0, s39, 40960
    s_add_u32 s62, s37, 295296
    buffer_load_dwordx4 v1, s[12:15], s62 offen offset:0  lds
    ds_read_b64_tr_b16 a[160:161], v17 offset:8192
    ds_read_b64_tr_b16 a[162:163], v17 offset:8704
    v_mfma_f32_32x32x16_bf16 v[48:63], a[164:167], a[44:47], v[48:63]
    v_max_f32 v113, 0, v113
    ds_read_b64_tr_b16 a[164:165], v18 offset:8192
    ds_read_b64_tr_b16 a[166:167], v18 offset:8704
    v_mfma_f32_32x32x16_bf16 v[64:79], a[168:171], a[44:47], v[64:79]
    v_mul_f32 v112, v112, v144
    buffer_load_dwordx4 v2, s[12:15], s62 offen offset:1024  lds
    ds_read_b64_tr_b16 a[168:169], v17 offset:26624
    ds_read_b64_tr_b16 a[170:171], v17 offset:27136
    v_mfma_f32_32x32x16_bf16 v[80:95], a[172:175], a[44:47], v[80:95]
    v_mul_f32 v113, v113, v145
    ds_read_b64_tr_b16 a[172:173], v18 offset:26624
    ds_read_b64_tr_b16 a[174:175], v18 offset:27136
    s_waitcnt lgkmcnt(8)
    v_mfma_f32_32x32x16_bf16 v[32:47], a[144:147], a[48:51], v[32:47]
    v_cvt_pk_bf16_f32 v184, v112, v113
    buffer_load_dwordx4 v3, s[12:15], s62 offen offset:2048  lds
    ds_read_b64_tr_b16 a[144:145], v17 offset:10240
    ds_read_b64_tr_b16 a[146:147], v17 offset:10752
    v_mfma_f32_32x32x16_bf16 v[48:63], a[148:151], a[48:51], v[48:63]
    v_max_f32 v114, 0, v114
    ds_read_b64_tr_b16 a[148:149], v18 offset:10240
    ds_read_b64_tr_b16 a[150:151], v18 offset:10752
    v_mfma_f32_32x32x16_bf16 v[64:79], a[152:155], a[48:51], v[64:79]
    v_max_f32 v115, 0, v115
    buffer_load_dwordx4 v4, s[12:15], s62 offen offset:3072  lds
    ds_read_b64_tr_b16 a[152:153], v17 offset:28672
    ds_read_b64_tr_b16 a[154:155], v17 offset:29184
    v_mfma_f32_32x32x16_bf16 v[80:95], a[156:159], a[48:51], v[80:95]
    v_mul_f32 v114, v114, v146
    ds_read_b64_tr_b16 a[156:157], v18 offset:28672
    ds_read_b64_tr_b16 a[158:159], v18 offset:29184
    s_waitcnt lgkmcnt(8)
    v_mfma_f32_32x32x16_bf16 v[32:47], a[160:163], a[52:55], v[32:47]
    v_mul_f32 v115, v115, v147
    s_add_u32 m0, s39, 45056
    s_add_u32 s62, s37, 590208
    buffer_load_dwordx4 v1, s[12:15], s62 offen offset:0  lds
    ds_read_b64_tr_b16 a[160:161], v17 offset:12288
    ds_read_b64_tr_b16 a[162:163], v17 offset:12800
    v_mfma_f32_32x32x16_bf16 v[48:63], a[164:167], a[52:55], v[48:63]
    v_cvt_pk_bf16_f32 v185, v114, v115
    ds_read_b64_tr_b16 a[164:165], v18 offset:12288
    ds_read_b64_tr_b16 a[166:167], v18 offset:12800
    v_mfma_f32_32x32x16_bf16 v[64:79], a[168:171], a[52:55], v[64:79]
    v_max_f32 v116, 0, v116
    s_add_u32 s64, s80, 1327104
    buffer_load_dword v253, v10, s[12:15], s64 offen
    ds_read_b64_tr_b16 a[168:169], v17 offset:30720
    ds_read_b64_tr_b16 a[170:171], v17 offset:31232
    v_mfma_f32_32x32x16_bf16 v[80:95], a[172:175], a[52:55], v[80:95]
    v_max_f32 v117, 0, v117
    s_add_u32 s64, s80, 2654208
    buffer_load_dword v253, v10, s[12:15], s64 offen
    ds_read_b64_tr_b16 a[172:173], v18 offset:30720
    ds_read_b64_tr_b16 a[174:175], v18 offset:31232
    s_waitcnt lgkmcnt(8)
    v_mfma_f32_32x32x16_bf16 v[32:47], a[144:147], a[56:59], v[32:47]
    v_mul_f32 v116, v116, v148
    ds_read_b64_tr_b16 a[144:145], v17 offset:14336
    ds_read_b64_tr_b16 a[146:147], v17 offset:14848
    v_mfma_f32_32x32x16_bf16 v[48:63], a[148:151], a[56:59], v[48:63]
    v_mul_f32 v117, v117, v149
    ds_read_b64_tr_b16 a[148:149], v18 offset:14336
    ds_read_b64_tr_b16 a[150:151], v18 offset:14848
    v_mfma_f32_32x32x16_bf16 v[64:79], a[152:155], a[56:59], v[64:79]
    v_cvt_pk_bf16_f32 v186, v116, v117
    ds_read_b64_tr_b16 a[152:153], v17 offset:32768
    ds_read_b64_tr_b16 a[154:155], v17 offset:33280
    v_mfma_f32_32x32x16_bf16 v[80:95], a[156:159], a[56:59], v[80:95]
    v_max_f32 v118, 0, v118
    ds_read_b64_tr_b16 a[156:157], v18 offset:32768
    ds_read_b64_tr_b16 a[158:159], v18 offset:33280
    s_waitcnt lgkmcnt(8)
    v_mfma_f32_32x32x16_bf16 v[32:47], a[160:163], a[60:63], v[32:47]
    v_max_f32 v119, 0, v119
    ds_read_b64_tr_b16 a[160:161], v17 offset:16384
    ds_read_b64_tr_b16 a[162:163], v17 offset:16896
    v_mfma_f32_32x32x16_bf16 v[48:63], a[164:167], a[60:63], v[48:63]
    v_mul_f32 v118, v118, v150
    ds_read_b64_tr_b16 a[164:165], v18 offset:16384
    ds_read_b64_tr_b16 a[166:167], v18 offset:16896
    v_mfma_f32_32x32x16_bf16 v[64:79], a[168:171], a[60:63], v[64:79]
    v_mul_f32 v119, v119, v151
    ds_read_b64_tr_b16 a[168:169], v17 offset:34816
    ds_read_b64_tr_b16 a[170:171], v17 offset:35328
    v_mfma_f32_32x32x16_bf16 v[80:95], a[172:175], a[60:63], v[80:95]
    v_cvt_pk_bf16_f32 v187, v118, v119
    ds_read_b64_tr_b16 a[172:173], v18 offset:34816
    ds_read_b64_tr_b16 a[174:175], v18 offset:35328
    s_waitcnt lgkmcnt(8)
    v_mfma_f32_32x32x16_bf16 v[32:47], a[144:147], a[64:67], v[32:47]
    s_waitcnt vmcnt(26)
    s_barrier
    s_add_u32 s63, s51, 6144
    buffer_store_dwordx4 v[184:187], v0, s[20:23], s63 offen sc1
    v_max_f32 v120, 0, v120
    ds_read_b64_tr_b16 a[144:145], v19 offset:0
    ds_read_b64_tr_b16 a[146:147], v19 offset:512
    v_mfma_f32_32x32x16_bf16 v[48:63], a[148:151], a[64:67], v[48:63]
    v_max_f32 v121, 0, v121
    ds_read_b64_tr_b16 a[148:149], v20 offset:0
    ds_read_b64_tr_b16 a[150:151], v20 offset:512
    v_mfma_f32_32x32x16_bf16 v[64:79], a[152:155], a[64:67], v[64:79]
    v_mul_f32 v120, v120, v152
    ds_read_b64_tr_b16 a[152:153], v19 offset:18432
    ds_read_b64_tr_b16 a[154:155], v19 offset:18944
    v_mfma_f32_32x32x16_bf16 v[80:95], a[156:159], a[64:67], v[80:95]
    v_mul_f32 v121, v121, v153
    ds_read_b64_tr_b16 a[156:157], v20 offset:18432
    ds_read_b64_tr_b16 a[158:159], v20 offset:18944
    s_waitcnt lgkmcnt(8)
    v_mfma_f32_32x32x16_bf16 v[32:47], a[160:163], a[68:71], v[32:47]
    v_cvt_pk_bf16_f32 v188, v120, v121
    ds_read_b64_tr_b16 a[160:161], v19 offset:2048
    ds_read_b64_tr_b16 a[162:163], v19 offset:2560
    v_mfma_f32_32x32x16_bf16 v[48:63], a[164:167], a[68:71], v[48:63]
    v_max_f32 v122, 0, v122
    ds_read_b64_tr_b16 a[164:165], v20 offset:2048
    ds_read_b64_tr_b16 a[166:167], v20 offset:2560
    v_mfma_f32_32x32x16_bf16 v[64:79], a[168:171], a[68:71], v[64:79]
    v_max_f32 v123, 0, v123
    ds_read_b64_tr_b16 a[168:169], v19 offset:20480
    ds_read_b64_tr_b16 a[170:171], v19 offset:20992
    v_mfma_f32_32x32x16_bf16 v[80:95], a[172:175], a[68:71], v[80:95]
    s_barrier
    v_mul_f32 v122, v122, v154
    ds_read_b64_tr_b16 a[172:173], v20 offset:20480
    ds_read_b64_tr_b16 a[174:175], v20 offset:20992
    s_waitcnt lgkmcnt(8)
    v_mfma_f32_32x32x16_bf16 v[32:47], a[144:147], a[72:75], v[32:47]
    s_cbranch_vccnz W0_4
    buffer_load_dwordx4 v[248:251], off, s[20:23], s73 sc1
W0_4:
    v_mul_f32 v123, v123, v155
    s_add_u32 m0, s39, 73728
    s_add_u32 s62, s37, 1327488
    buffer_load_dwordx4 v1, s[12:15], s62 offen offset:0  lds
    ds_read_b64_tr_b16 a[144:145], v19 offset:4096
    ds_read_b64_tr_b16 a[146:147], v19 offset:4608
    v_mfma_f32_32x32x16_bf16 v[48:63], a[148:151], a[72:75], v[48:63]
    v_cvt_pk_bf16_f32 v189, v122, v123
    ds_read_b64_tr_b16 a[148:149], v20 offset:4096
    ds_read_b64_tr_b16 a[150:151], v20 offset:4608
    v_mfma_f32_32x32x16_bf16 v[64:79], a[152:155], a[72:75], v[64:79]
    v_max_f32 v124, 0, v124
    buffer_load_dwordx4 v2, s[12:15], s62 offen offset:1024  lds
    ds_read_b64_tr_b16 a[152:153], v19 offset:22528
    ds_read_b64_tr_b16 a[154:155], v19 offset:23040
    v_mfma_f32_32x32x16_bf16 v[80:95], a[156:159], a[72:75], v[80:95]
    v_max_f32 v125, 0, v125
    ds_read_b64_tr_b16 a[156:157], v20 offset:22528
    ds_read_b64_tr_b16 a[158:159], v20 offset:23040
    s_waitcnt lgkmcnt(8)
    v_mfma_f32_32x32x16_bf16 v[32:47], a[160:163], a[76:79], v[32:47]
    v_mul_f32 v124, v124, v156
    buffer_load_dwordx4 v3, s[12:15], s62 offen offset:2048  lds
    ds_read_b64_tr_b16 a[160:161], v19 offset:6144
    ds_read_b64_tr_b16 a[162:163], v19 offset:6656
    v_mfma_f32_32x32x16_bf16 v[48:63], a[164:167], a[76:79], v[48:63]
    v_mul_f32 v125, v125, v157
    ds_read_b64_tr_b16 a[164:165], v20 offset:6144
    ds_read_b64_tr_b16 a[166:167], v20 offset:6656
    v_mfma_f32_32x32x16_bf16 v[64:79], a[168:171], a[76:79], v[64:79]
    v_cvt_pk_bf16_f32 v190, v124, v125
    buffer_load_dwordx4 v4, s[12:15], s62 offen offset:3072  lds
    ds_read_b64_tr_b16 a[168:169], v19 offset:24576
    ds_read_b64_tr_b16 a[170:171], v19 offset:25088
    v_mfma_f32_32x32x16_bf16 v[80:95], a[172:175], a[76:79], v[80:95]
    v_max_f32 v126, 0, v126
    ds_read_b64_tr_b16 a[172:173], v20 offset:24576
    ds_read_b64_tr_b16 a[174:175], v20 offset:25088
    s_waitcnt lgkmcnt(8)
    v_mfma_f32_32x32x16_bf16 v[32:47], a[144:147], a[80:83], v[32:47]
    v_max_f32 v127, 0, v127
    s_add_u32 m0, s39, 77824
    s_add_u32 s62, s37, 1622400
    buffer_load_dwordx4 v1, s[12:15], s62 offen offset:0  lds
    ds_read_b64_tr_b16 a[144:145], v19 offset:8192
    ds_read_b64_tr_b16 a[146:147], v19 offset:8704
    v_mfma_f32_32x32x16_bf16 v[48:63], a[148:151], a[80:83], v[48:63]
    v_mul_f32 v126, v126, v158
    ds_read_b64_tr_b16 a[148:149], v20 offset:8192
    ds_read_b64_tr_b16 a[150:151], v20 offset:8704
    v_mfma_f32_32x32x16_bf16 v[64:79], a[152:155], a[80:83], v[64:79]
    v_mul_f32 v127, v127, v159
    buffer_load_dwordx4 v2, s[12:15], s62 offen offset:1024  lds
    ds_read_b64_tr_b16 a[152:153], v19 offset:26624
    ds_read_b64_tr_b16 a[154:155], v19 offset:27136
    v_mfma_f32_32x32x16_bf16 v[80:95], a[156:159], a[80:83], v[80:95]
    v_cvt_pk_bf16_f32 v191, v126, v127
    ds_read_b64_tr_b16 a[156:157], v20 offset:26624
    ds_read_b64_tr_b16 a[158:159], v20 offset:27136
    s_waitcnt lgkmcnt(8)
    v_mfma_f32_32x32x16_bf16 v[32:47], a[160:163], a[84:87], v[32:47]
    s_add_u32 s63, s51, 7168
    buffer_store_dwordx4 v[188:191], v0, s[20:23], s63 offen sc1
    buffer_load_dwordx4 v3, s[12:15], s62 offen offset:2048  lds
    ds_read_b64_tr_b16 a[160:161], v19 offset:10240
    ds_read_b64_tr_b16 a[162:163], v19 offset:10752
    v_mfma_f32_32x32x16_bf16 v[48:63], a[164:167], a[84:87], v[48:63]
    ds_read_b64_tr_b16 a[164:165], v20 offset:10240
    ds_read_b64_tr_b16 a[166:167], v20 offset:10752
    v_mfma_f32_32x32x16_bf16 v[64:79], a[168:171], a[84:87], v[64:79]
    buffer_load_dwordx4 v4, s[12:15], s62 offen offset:3072  lds
    ds_read_b64_tr_b16 a[168:169], v19 offset:28672
    ds_read_b64_tr_b16 a[170:171], v19 offset:29184
    v_mfma_f32_32x32x16_bf16 v[80:95], a[172:175], a[84:87], v[80:95]
    ds_read_b64_tr_b16 a[172:173], v20 offset:28672
    ds_read_b64_tr_b16 a[174:175], v20 offset:29184
    s_waitcnt lgkmcnt(8)
    v_mfma_f32_32x32x16_bf16 v[32:47], a[144:147], a[88:91], v[32:47]
    s_add_u32 m0, s39, 81920
    s_add_u32 s62, s37, 1917312
    buffer_load_dwordx4 v1, s[12:15], s62 offen offset:0  lds
    ds_read_b64_tr_b16 a[144:145], v19 offset:12288
    ds_read_b64_tr_b16 a[146:147], v19 offset:12800
    v_mfma_f32_32x32x16_bf16 v[48:63], a[148:151], a[88:91], v[48:63]
    ds_read_b64_tr_b16 a[148:149], v20 offset:12288
    ds_read_b64_tr_b16 a[150:151], v20 offset:12800
    v_mfma_f32_32x32x16_bf16 v[64:79], a[152:155], a[88:91], v[64:79]
    s_add_u32 s64, s80, 3981312
    buffer_load_dword v253, v10, s[12:15], s64 offen
    ds_read_b64_tr_b16 a[152:153], v19 offset:30720
    ds_read_b64_tr_b16 a[154:155], v19 offset:31232
    v_mfma_f32_32x32x16_bf16 v[80:95], a[156:159], a[88:91], v[80:95]
    s_add_u32 s64, s81, 0
    buffer_load_dword v253, v255, s[16:19], s64 offen
    ds_read_b64_tr_b16 a[156:157], v20 offset:30720
    ds_read_b64_tr_b16 a[158:159], v20 offset:31232
    s_waitcnt lgkmcnt(8)
    v_mfma_f32_32x32x16_bf16 v[32:47], a[160:163], a[92:95], v[32:47]
    ds_read_b64_tr_b16 a[160:161], v19 offset:14336
    ds_read_b64_tr_b16 a[162:163], v19 offset:14848
    v_mfma_f32_32x32x16_bf16 v[48:63], a[164:167], a[92:95], v[48:63]
    ds_read_b64_tr_b16 a[164:165], v20 offset:14336
    ds_read_b64_tr_b16 a[166:167], v20 offset:14848
    v_mfma_f32_32x32x16_bf16 v[64:79], a[168:171], a[92:95], v[64:79]
    ds_read_b64_tr_b16 a[168:169], v19 offset:32768
    ds_read_b64_tr_b16 a[170:171], v19 offset:33280
    v_mfma_f32_32x32x16_bf16 v[80:95], a[172:175], a[92:95], v[80:95]
    ds_read_b64_tr_b16 a[172:173], v20 offset:32768
    ds_read_b64_tr_b16 a[174:175], v20 offset:33280
    s_waitcnt lgkmcnt(8)
    v_mfma_f32_32x32x16_bf16 v[32:47], a[144:147], a[96:99], v[32:47]
    ds_read_b64_tr_b16 a[144:145], v19 offset:16384
    ds_read_b64_tr_b16 a[146:147], v19 offset:16896
    v_mfma_f32_32x32x16_bf16 v[48:63], a[148:151], a[96:99], v[48:63]
    ds_read_b64_tr_b16 a[148:149], v20 offset:16384
    ds_read_b64_tr_b16 a[150:151], v20 offset:16896
    v_mfma_f32_32x32x16_bf16 v[64:79], a[152:155], a[96:99], v[64:79]
    ds_read_b64_tr_b16 a[152:153], v19 offset:34816
    ds_read_b64_tr_b16 a[154:155], v19 offset:35328
    v_mfma_f32_32x32x16_bf16 v[80:95], a[156:159], a[96:99], v[80:95]
    ds_read_b64_tr_b16 a[156:157], v20 offset:34816
    ds_read_b64_tr_b16 a[158:159], v20 offset:35328
    s_waitcnt lgkmcnt(8)
    v_mfma_f32_32x32x16_bf16 v[32:47], a[160:163], a[100:103], v[32:47]
    s_waitcnt vmcnt(28)
    s_cbranch_vccnz W0_5
    s_waitcnt vmcnt(12)
    s_add_u32 s78, s72, 1
    v_subrev_u32 v248, s78, v248
    v_subrev_u32 v249, s78, v249
    v_subrev_u32 v250, s78, v250
    v_subrev_u32 v251, s78, v251
    v_or_b32 v248, v248, v249
    v_or_b32 v250, v250, v251
    v_or_b32 v248, v248, v250
    v_cmp_gt_u32 s[82:83], 8, v248
    s_nop 1
    s_cmp_eq_u64 s[82:83], -1
    s_cbranch_scc0 SLOW1
OK1:
W0_5:
    s_barrier
    ds_read_b64_tr_b16 a[160:161], v13 offset:0
    ds_read_b64_tr_b16 a[162:163], v13 offset:512
    v_mfma_f32_32x32x16_bf16 v[48:63], a[164:167], a[100:103], v[48:63]
    ds_read_b64_tr_b16 a[164:165], v14 offset:0
    ds_read_b64_tr_b16 a[166:167], v14 offset:512
    v_mfma_f32_32x32x16_bf16 v[64:79], a[168:171], a[100:103], v[64:79]
    s_add_u32 s64, s52, 0
    buffer_load_dwordx4 a[176:179], v0, s[20:23], s64 offen sc1
    ds_read_b64_tr_b16 a[168:169], v13 offset:18432
    ds_read_b64_tr_b16 a[170:171], v13 offset:18944
    v_mfma_f32_32x32x16_bf16 v[80:95], a[172:175], a[100:103], v[80:95]
    ds_read_b64_tr_b16 a[172:173], v14 offset:18432
    ds_read_b64_tr_b16 a[174:175], v14 offset:18944
    s_waitcnt lgkmcnt(8)
    v_mfma_f32_32x32x16_bf16 v[32:47], a[144:147], a[104:107], v[32:47]
    ds_read_b64_tr_b16 a[144:145], v13 offset:2048
    ds_read_b64_tr_b16 a[146:147], v13 offset:2560
    v_mfma_f32_32x32x16_bf16 v[48:63], a[148:151], a[104:107], v[48:63]
    ds_read_b64_tr_b16 a[148:149], v14 offset:2048
    ds_read_b64_tr_b16 a[150:151], v14 offset:2560
    v_mfma_f32_32x32x16_bf16 v[64:79], a[152:155], a[104:107], v[64:79]
    ds_read_b64_tr_b16 a[152:153], v13 offset:20480
    ds_read_b64_tr_b16 a[154:155], v13 offset:20992
    v_mfma_f32_32x32x16_bf16 v[80:95], a[156:159], a[104:107], v[80:95]
    s_barrier
    ds_read_b64_tr_b16 a[156:157], v14 offset:20480
    ds_read_b64_tr_b16 a[158:159], v14 offset:20992
    s_waitcnt lgkmcnt(8)
    v_mfma_f32_32x32x16_bf16 v[32:47], a[160:163], a[108:111], v[32:47]
    s_add_u32 m0, s39, 110592
    s_add_u32 s62, s37, 2654592
    buffer_load_dwordx4 v1, s[12:15], s62 offen offset:0  lds
    ds_read_b64_tr_b16 a[160:161], v13 offset:4096
    ds_read_b64_tr_b16 a[162:163], v13 offset:4608
    v_mfma_f32_32x32x16_bf16 v[48:63], a[164:167], a[108:111], v[48:63]
    ds_read_b64_tr_b16 a[164:165], v14 offset:4096
    ds_read_b64_tr_b16 a[166:167], v14 offset:4608
    v_mfma_f32_32x32x16_bf16 v[64:79], a[168:171], a[108:111], v[64:79]
    buffer_load_dwordx4 v2, s[12:15], s62 offen offset:1024  lds
    ds_read_b64_tr_b16 a[168:169], v13 offset:22528
    ds_read_b64_tr_b16 a[170:171], v13 offset:23040
    v_mfma_f32_32x32x16_bf16 v[80:95], a[172:175], a[108:111], v[80:95]
    ds_read_b64_tr_b16 a[172:173], v14 offset:22528
    ds_read_b64_tr_b16 a[174:175], v14 offset:23040
    s_waitcnt lgkmcnt(8)
    v_mfma_f32_32x32x16_bf16 v[32:47], a[144:147], a[112:115], v[32:47]
    buffer_load_dwordx4 v3, s[12:15], s62 offen offset:2048  lds
    ds_read_b64_tr_b16 a[144:145], v13 offset:6144
    ds_read_b64_tr_b16 a[146:147], v13 offset:6656
    v_mfma_f32_32x32x16_bf16 v[48:63], a[148:151], a[112:115], v[48:63]
    ds_read_b64_tr_b16 a[148:149], v14 offset:6144
    ds_read_b64_tr_b16 a[150:151], v14 offset:6656
    v_mfma_f32_32x32x16_bf16 v[64:79], a[152:155], a[112:115], v[64:79]
    buffer_load_dwordx4 v4, s[12:15], s62 offen offset:3072  lds
    ds_read_b64_tr_b16 a[152:153], v13 offset:24576
    ds_read_b64_tr_b16 a[154:155], v13 offset:25088
    v_mfma_f32_32x32x16_bf16 v[80:95], a[156:159], a[112:115], v[80:95]
    ds_read_b64_tr_b16 a[156:157], v14 offset:24576
    ds_read_b64_tr_b16 a[158:159], v14 offset:25088
    s_waitcnt lgkmcnt(8)
    v_mfma_f32_32x32x16_bf16 v[32:47], a[160:163], a[116:119], v[32:47]
    s_add_u32 m0, s39, 114688
    s_add_u32 s62, s37, 2949504
    buffer_load_dwordx4 v1, s[12:15], s62 offen offset:0  lds
    ds_read_b64_tr_b16 a[160:161], v13 offset:8192
    ds_read_b64_tr_b16 a[162:163], v13 offset:8704
    v_mfma_f32_32x32x16_bf16 v[48:63], a[164:167], a[116:119], v[48:63]
    ds_read_b64_tr_b16 a[164:165], v14 offset:8192
    ds_read_b64_tr_b16 a[166:167], v14 offset:8704
    v_mfma_f32_32x32x16_bf16 v[64:79], a[168:171], a[116:119], v[64:79]
    buffer_load_dwordx4 v2, s[12:15], s62 offen offset:1024  lds
    ds_read_b64_tr_b16 a[168:169], v13 offset:26624
    ds_read_b64_tr_b16 a[170:171], v13 offset:27136
    v_mfma_f32_32x32x16_bf16 v[80:95], a[172:175], a[116:119], v[80:95]
    ds_read_b64_tr_b16 a[172:173], v14 offset:26624
    ds_read_b64_tr_b16 a[174:175], v14 offset:27136
    s_waitcnt lgkmcnt(8)
    v_mfma_f32_32x32x16_bf16 v[32:47], a[144:147], a[120:123], v[32:47]
    buffer_load_dwordx4 v3, s[12:15], s62 offen offset:2048  lds
    ds_read_b64_tr_b16 a[144:145], v13 offset:10240
    ds_read_b64_tr_b16 a[146:147], v13 offset:10752
    v_mfma_f32_32x32x16_bf16 v[48:63], a[148:151], a[120:123], v[48:63]
    ds_read_b64_tr_b16 a[148:149], v14 offset:10240
    ds_read_b64_tr_b16 a[150:151], v14 offset:10752
    v_mfma_f32_32x32x16_bf16 v[64:79], a[152:155], a[120:123], v[64:79]
    buffer_load_dwordx4 v4, s[12:15], s62 offen offset:3072  lds
    ds_read_b64_tr_b16 a[152:153], v13 offset:28672
    ds_read_b64_tr_b16 a[154:155], v13 offset:29184
    v_mfma_f32_32x32x16_bf16 v[80:95], a[156:159], a[120:123], v[80:95]
    ds_read_b64_tr_b16 a[156:157], v14 offset:28672
    ds_read_b64_tr_b16 a[158:159], v14 offset:29184
    s_waitcnt lgkmcnt(8)
    v_mfma_f32_32x32x16_bf16 v[32:47], a[160:163], a[124:127], v[32:47]
    s_add_u32 m0, s39, 118784
    s_add_u32 s62, s37, 3244416
    buffer_load_dwordx4 v1, s[12:15], s62 offen offset:0  lds
    ds_read_b64_tr_b16 a[160:161], v13 offset:12288
    ds_read_b64_tr_b16 a[162:163], v13 offset:12800
    v_mfma_f32_32x32x16_bf16 v[48:63], a[164:167], a[124:127], v[48:63]
    ds_read_b64_tr_b16 a[164:165], v14 offset:12288
    ds_read_b64_tr_b16 a[166:167], v14 offset:12800
    v_mfma_f32_32x32x16_bf16 v[64:79], a[168:171], a[124:127], v[64:79]
    s_add_u32 s64, s81, 1152
    buffer_load_dword v253, v255, s[16:19], s64 offen
    s_add_u32 s64, s52, 1024
    buffer_load_dwordx4 a[180:183], v0, s[20:23], s64 offen sc1
    ds_read_b64_tr_b16 a[168:169], v13 offset:30720
    ds_read_b64_tr_b16 a[170:171], v13 offset:31232
    v_mfma_f32_32x32x16_bf16 v[80:95], a[172:175], a[124:127], v[80:95]
    s_add_u32 s64, s81, 2304
    buffer_load_dword v253, v255, s[16:19], s64 offen
    ds_read_b64_tr_b16 a[172:173], v14 offset:30720
    ds_read_b64_tr_b16 a[174:175], v14 offset:31232
    s_waitcnt lgkmcnt(8)
    v_mfma_f32_32x32x16_bf16 v[32:47], a[144:147], a[128:131], v[32:47]
    ds_read_b64_tr_b16 a[144:145], v13 offset:14336
    ds_read_b64_tr_b16 a[146:147], v13 offset:14848
    v_mfma_f32_32x32x16_bf16 v[48:63], a[148:151], a[128:131], v[48:63]
    ds_read_b64_tr_b16 a[148:149], v14 offset:14336
    ds_read_b64_tr_b16 a[150:151], v14 offset:14848
    v_mfma_f32_32x32x16_bf16 v[64:79], a[152:155], a[128:131], v[64:79]
    s_add_u32 s64, s52, 2048
    buffer_load_dwordx4 a[184:187], v0, s[20:23], s64 offen sc1
    ds_read_b64_tr_b16 a[152:153], v13 offset:32768
    ds_read_b64_tr_b16 a[154:155], v13 offset:33280
    v_mfma_f32_32x32x16_bf16 v[80:95], a[156:159], a[128:131], v[80:95]
    ds_read_b64_tr_b16 a[156:157], v14 offset:32768
    ds_read_b64_tr_b16 a[158:159], v14 offset:33280
    s_waitcnt lgkmcnt(8)
    v_mfma_f32_32x32x16_bf16 v[32:47], a[160:163], a[132:135], v[32:47]
    ds_read_b64_tr_b16 a[160:161], v13 offset:16384
    ds_read_b64_tr_b16 a[162:163], v13 offset:16896
    v_mfma_f32_32x32x16_bf16 v[48:63], a[164:167], a[132:135], v[48:63]
    ds_read_b64_tr_b16 a[164:165], v14 offset:16384
    ds_read_b64_tr_b16 a[166:167], v14 offset:16896
    v_mfma_f32_32x32x16_bf16 v[64:79], a[168:171], a[132:135], v[64:79]
    s_add_u32 s64, s52, 3072
    buffer_load_dwordx4 a[188:191], v0, s[20:23], s64 offen sc1
    ds_read_b64_tr_b16 a[168:169], v13 offset:34816
    ds_read_b64_tr_b16 a[170:171], v13 offset:35328
    v_mfma_f32_32x32x16_bf16 v[80:95], a[172:175], a[132:135], v[80:95]
    ds_read_b64_tr_b16 a[172:173], v14 offset:34816
    ds_read_b64_tr_b16 a[174:175], v14 offset:35328
    s_waitcnt lgkmcnt(8)
    v_mfma_f32_32x32x16_bf16 v[32:47], a[144:147], a[136:139], v[32:47]
    s_waitcnt vmcnt(30)
    s_waitcnt vmcnt(20)
    s_barrier
    s_cbranch_vccnz W0_6
    s_add_u32 s78, s72, 2
    v_mov_b32 v252, s78
    buffer_store_dword v252, off, s[20:23], s76 sc1
W0_6:
    ds_read_b64_tr_b16 a[144:145], v15 offset:0
    ds_read_b64_tr_b16 a[146:147], v15 offset:512
    v_mfma_f32_32x32x16_bf16 v[48:63], a[148:151], a[136:139], v[48:63]
    ds_read_b64_tr_b16 a[148:149], v16 offset:0
    ds_read_b64_tr_b16 a[150:151], v16 offset:512
    v_mfma_f32_32x32x16_bf16 v[64:79], a[152:155], a[136:139], v[64:79]
    s_add_u32 s64, s53, 0
    buffer_load_dwordx4 a[192:195], v0, s[20:23], s64 offen sc1
    ds_read_b64_tr_b16 a[152:153], v15 offset:18432
    ds_read_b64_tr_b16 a[154:155], v15 offset:18944
    v_mfma_f32_32x32x16_bf16 v[80:95], a[156:159], a[136:139], v[80:95]
    ds_read_b64_tr_b16 a[156:157], v16 offset:18432
    ds_read_b64_tr_b16 a[158:159], v16 offset:18944
    s_waitcnt lgkmcnt(8)
    v_mfma_f32_32x32x16_bf16 v[32:47], a[160:163], a[140:143], v[32:47]
    ds_read_b64_tr_b16 a[160:161], v15 offset:2048
    ds_read_b64_tr_b16 a[162:163], v15 offset:2560
    v_mfma_f32_32x32x16_bf16 v[48:63], a[164:167], a[140:143], v[48:63]
    ds_read_b64_tr_b16 a[164:165], v16 offset:2048
    ds_read_b64_tr_b16 a[166:167], v16 offset:2560
    v_mfma_f32_32x32x16_bf16 v[64:79], a[168:171], a[140:143], v[64:79]
    ds_read_b64_tr_b16 a[168:169], v15 offset:20480
    ds_read_b64_tr_b16 a[170:171], v15 offset:20992
    v_mfma_f32_32x32x16_bf16 v[80:95], a[172:175], a[140:143], v[80:95]
    s_barrier
    ds_read_b64_tr_b16 a[172:173], v16 offset:20480
    ds_read_b64_tr_b16 a[174:175], v16 offset:20992
    s_waitcnt lgkmcnt(8)
    v_mfma_f32_32x32x16_bf16 v[96:111], a[144:147], a[0:3], 0
    s_add_u32 m0, s39, 0
    s_add_u32 s62, s37, 3981696
    buffer_load_dwordx4 v1, s[12:15], s62 offen offset:0  lds
    ds_read_b64_tr_b16 a[144:145], v15 offset:4096
    ds_read_b64_tr_b16 a[146:147], v15 offset:4608
    v_mfma_f32_32x32x16_bf16 v[112:127], a[148:151], a[0:3], 0
    ds_read_b64_tr_b16 a[148:149], v16 offset:4096
    ds_read_b64_tr_b16 a[150:151], v16 offset:4608
    v_mfma_f32_32x32x16_bf16 v[128:143], a[152:155], a[0:3], 0
    buffer_load_dwordx4 v2, s[12:15], s62 offen offset:1024  lds
    ds_read_b64_tr_b16 a[152:153], v15 offset:22528
    ds_read_b64_tr_b16 a[154:155], v15 offset:23040
    v_mfma_f32_32x32x16_bf16 v[144:159], a[156:159], a[0:3], 0
    ds_read_b64_tr_b16 a[156:157], v16 offset:22528
    ds_read_b64_tr_b16 a[158:159], v16 offset:23040
    s_waitcnt lgkmcnt(8)
    v_mfma_f32_32x32x16_bf16 v[96:111], a[160:163], a[4:7], v[96:111]
    v_max_f32 v32, 0, v32
    buffer_load_dwordx4 v3, s[12:15], s62 offen offset:2048  lds
    ds_read_b64_tr_b16 a[160:161], v15 offset:6144
    ds_read_b64_tr_b16 a[162:163], v15 offset:6656
    v_mfma_f32_32x32x16_bf16 v[112:127], a[164:167], a[4:7], v[112:127]
    v_max_f32 v33, 0, v33
    ds_read_b64_tr_b16 a[164:165], v16 offset:6144
    ds_read_b64_tr_b16 a[166:167], v16 offset:6656
    v_mfma_f32_32x32x16_bf16 v[128:143], a[168:171], a[4:7], v[128:143]
    v_mul_f32 v32, v32, v64
    buffer_load_dwordx4 v4, s[12:15], s62 offen offset:3072  lds
    ds_read_b64_tr_b16 a[168:169], v15 offset:24576
    ds_read_b64_tr_b16 a[170:171], v15 offset:25088
    v_mfma_f32_32x32x16_bf16 v[144:159], a[172:175], a[4:7], v[144:159]
    v_mul_f32 v33, v33, v65
    ds_read_b64_tr_b16 a[172:173], v16 offset:24576
    ds_read_b64_tr_b16 a[174:175], v16 offset:25088
    s_waitcnt lgkmcnt(8)
    v_mfma_f32_32x32x16_bf16 v[96:111], a[144:147], a[8:11], v[96:111]
    v_cvt_pk_bf16_f32 v192, v32, v33
    s_add_u32 m0, s39, 4096
    s_add_u32 s62, s37, 4276608
    buffer_load_dwordx4 v1, s[12:15], s62 offen offset:0  lds
    ds_read_b64_tr_b16 a[144:145], v15 offset:8192
    ds_read_b64_tr_b16 a[146:147], v15 offset:8704
    v_mfma_f32_32x32x16_bf16 v[112:127], a[148:151], a[8:11], v[112:127]
    v_max_f32 v34, 0, v34
    ds_read_b64_tr_b16 a[148:149], v16 offset:8192
    ds_read_b64_tr_b16 a[150:151], v16 offset:8704
    v_mfma_f32_32x32x16_bf16 v[128:143], a[152:155], a[8:11], v[128:143]
    v_max_f32 v35, 0, v35
    buffer_load_dwordx4 v2, s[12:15], s62 offen offset:1024  lds
    ds_read_b64_tr_b16 a[152:153], v15 offset:26624
    ds_read_b64_tr_b16 a[154:155], v15 offset:27136
    v_mfma_f32_32x32x16_bf16 v[144:159], a[156:159], a[8:11], v[144:159]
    v_mul_f32 v34, v34, v66
    ds_read_b64_tr_b16 a[156:157], v16 offset:26624
    ds_read_b64_tr_b16 a[158:159], v16 offset:27136
    s_waitcnt lgkmcnt(8)
    v_mfma_f32_32x32x16_bf16 v[96:111], a[160:163], a[12:15], v[96:111]
    v_mul_f32 v35, v35, v67
    buffer_load_dwordx4 v3, s[12:15], s62 offen offset:2048  lds
    ds_read_b64_tr_b16 a[160:161], v15 offset:10240
    ds_read_b64_tr_b16 a[162:163], v15 offset:10752
    v_mfma_f32_32x32x16_bf16 v[112:127], a[164:167], a[12:15], v[112:127]
    v_cvt_pk_bf16_f32 v193, v34, v35
    ds_read_b64_tr_b16 a[164:165], v16 offset:10240
    ds_read_b64_tr_b16 a[166:167], v16 offset:10752
    v_mfma_f32_32x32x16_bf16 v[128:143], a[168:171], a[12:15], v[128:143]
    v_max_f32 v36, 0, v36
    buffer_load_dwordx4 v4, s[12:15], s62 offen offset:3072  lds
    ds_read_b64_tr_b16 a[168:169], v15 offset:28672
    ds_read_b64_tr_b16 a[170:171], v15 offset:29184
    v_mfma_f32_32x32x16_bf16 v[144:159], a[172:175], a[12:15], v[144:159]
    v_max_f32 v37, 0, v37
    ds_read_b64_tr_b16 a[172:173], v16 offset:28672
    ds_read_b64_tr_b16 a[174:175], v16 offset:29184
    s_waitcnt lgkmcnt(8)
    v_mfma_f32_32x32x16_bf16 v[96:111], a[144:147], a[16:19], v[96:111]
    v_mul_f32 v36, v36, v68
    s_add_u32 m0, s39, 8192
    s_add_u32 s62, s37, 4571520
    buffer_load_dwordx4 v1, s[12:15], s62 offen offset:0  lds
    ds_read_b64_tr_b16 a[144:145], v15 offset:12288
    ds_read_b64_tr_b16 a[146:147], v15 offset:12800
    v_mfma_f32_32x32x16_bf16 v[112:127], a[148:151], a[16:19], v[112:127]
    v_mul_f32 v37, v37, v69
    ds_read_b64_tr_b16 a[148:149], v16 offset:12288
    ds_read_b64_tr_b16 a[150:151], v16 offset:12800
    v_mfma_f32_32x32x16_bf16 v[128:143], a[152:155], a[16:19], v[128:143]
    v_cvt_pk_bf16_f32 v194, v36, v37
    s_add_u32 s64, s81, 3456
    buffer_load_dword v253, v255, s[16:19], s64 offen
    s_add_u32 s64, s53, 1024
    buffer_load_dwordx4 a[196:199], v0, s[20:23], s64 offen sc1
    ds_read_b64_tr_b16 a[152:153], v15 offset:30720
    ds_read_b64_tr_b16 a[154:155], v15 offset:31232
    v_mfma_f32_32x32x16_bf16 v[144:159], a[156:159], a[16:19], v[144:159]
    v_max_f32 v38, 0, v38
    s_add_u32 s64, s81, 4608
    buffer_load_dword v253, v255, s[16:19], s64 offen
    ds_read_b64_tr_b16 a[156:157], v16 offset:30720
    ds_read_b64_tr_b16 a[158:159], v16 offset:31232
    s_waitcnt lgkmcnt(8)
    v_mfma_f32_32x32x16_bf16 v[96:111], a[160:163], a[20:23], v[96:111]
    v_max_f32 v39, 0, v39
    ds_read_b64_tr_b16 a[160:161], v15 offset:14336
    ds_read_b64_tr_b16 a[162:163], v15 offset:14848
    v_mfma_f32_32x32x16_bf16 v[112:127], a[164:167], a[20:23], v[112:127]
    v_mul_f32 v38, v38, v70
    ds_read_b64_tr_b16 a[164:165], v16 offset:14336
    ds_read_b64_tr_b16 a[166:167], v16 offset:14848
    v_mfma_f32_32x32x16_bf16 v[128:143], a[168:171], a[20:23], v[128:143]
    v_mul_f32 v39, v39, v71
    s_add_u32 s64, s53, 2048
    buffer_load_dwordx4 a[200:203], v0, s[20:23], s64 offen sc1
    ds_read_b64_tr_b16 a[168:169], v15 offset:32768
    ds_read_b64_tr_b16 a[170:171], v15 offset:33280
    v_mfma_f32_32x32x16_bf16 v[144:159], a[172:175], a[20:23], v[144:159]
    v_cvt_pk_bf16_f32 v195, v38, v39
    ds_read_b64_tr_b16 a[172:173], v16 offset:32768
    ds_read_b64_tr_b16 a[174:175], v16 offset:33280
    s_waitcnt lgkmcnt(8)
    v_mfma_f32_32x32x16_bf16 v[96:111], a[144:147], a[24:27], v[96:111]
    s_add_u32 s63, s51, 8192
    buffer_store_dwordx4 v[192:195], v0, s[20:23], s63 offen sc1
    v_max_f32 v40, 0, v40
    ds_read_b64_tr_b16 a[144:145], v15 offset:16384
    ds_read_b64_tr_b16 a[146:147], v15 offset:16896
    v_mfma_f32_32x32x16_bf16 v[112:127], a[148:151], a[24:27], v[112:127]
    v_max_f32 v41, 0, v41
    ds_read_b64_tr_b16 a[148:149], v16 offset:16384
    ds_read_b64_tr_b16 a[150:151], v16 offset:16896
    v_mfma_f32_32x32x16_bf16 v[128:143], a[152:155], a[24:27], v[128:143]
    v_mul_f32 v40, v40, v72
    s_add_u32 s64, s53, 3072
    buffer_load_dwordx4 a[204:207], v0, s[20:23], s64 offen sc1
    ds_read_b64_tr_b16 a[152:153], v15 offset:34816
    ds_read_b64_tr_b16 a[154:155], v15 offset:35328
    v_mfma_f32_32x32x16_bf16 v[144:159], a[156:159], a[24:27], v[144:159]
    v_mul_f32 v41, v41, v73
    ds_read_b64_tr_b16 a[156:157], v16 offset:34816
    ds_read_b64_tr_b16 a[158:159], v16 offset:35328
    s_waitcnt lgkmcnt(8)
    v_mfma_f32_32x32x16_bf16 v[96:111], a[160:163], a[28:31], v[96:111]
    s_waitcnt vmcnt(33)
    s_barrier
    v_cvt_pk_bf16_f32 v196, v40, v41
    ds_read_b64_tr_b16 a[160:161], v17 offset:0
    ds_read_b64_tr_b16 a[162:163], v17 offset:512
    v_mfma_f32_32x32x16_bf16 v[112:127], a[164:167], a[28:31], v[112:127]
    v_max_f32 v42, 0, v42
    ds_read_b64_tr_b16 a[164:165], v18 offset:0
    ds_read_b64_tr_b16 a[166:167], v18 offset:512
    v_mfma_f32_32x32x16_bf16 v[128:143], a[168:171], a[28:31], v[128:143]
    v_max_f32 v43, 0, v43
    s_add_u32 s64, s54, 0
    buffer_load_dwordx4 a[208:211], v0, s[20:23], s64 offen sc1
    ds_read_b64_tr_b16 a[168:169], v17 offset:18432
    ds_read_b64_tr_b16 a[170:171], v17 offset:18944
    v_mfma_f32_32x32x16_bf16 v[144:159], a[172:175], a[28:31], v[144:159]
    v_mul_f32 v42, v42, v74
    ds_read_b64_tr_b16 a[172:173], v18 offset:18432
    ds_read_b64_tr_b16 a[174:175], v18 offset:18944
    s_waitcnt lgkmcnt(8)
    v_mfma_f32_32x32x16_bf16 v[96:111], a[144:147], a[32:35], v[96:111]
    v_mul_f32 v43, v43, v75
    ds_read_b64_tr_b16 a[144:145], v17 offset:2048
    ds_read_b64_tr_b16 a[146:147], v17 offset:2560
    v_mfma_f32_32x32x16_bf16 v[112:127], a[148:151], a[32:35], v[112:127]
    v_cvt_pk_bf16_f32 v197, v42, v43
    ds_read_b64_tr_b16 a[148:149], v18 offset:2048
    ds_read_b64_tr_b16 a[150:151], v18 offset:2560
    v_mfma_f32_32x32x16_bf16 v[128:143], a[152:155], a[32:35], v[128:143]
    v_max_f32 v44, 0, v44
    ds_read_b64_tr_b16 a[152:153], v17 offset:20480
    ds_read_b64_tr_b16 a[154:155], v17 offset:20992
    v_mfma_f32_32x32x16_bf16 v[144:159], a[156:159], a[32:35], v[144:159]
    s_barrier
    v_max_f32 v45, 0, v45
    ds_read_b64_tr_b16 a[156:157], v18 offset:20480
    ds_read_b64_tr_b16 a[158:159], v18 offset:20992
    s_waitcnt lgkmcnt(8)
    v_mfma_f32_32x32x16_bf16 v[96:111], a[160:163], a[36:39], v[96:111]
    v_mul_f32 v44, v44, v76
    s_add_u32 m0, s39, 36864
    s_add_u32 s62, s38, 0
    buffer_load_dwordx4 v5, s[12:15], s62 offen offset:0  lds
    ds_read_b64_tr_b16 a[160:161], v17 offset:4096
    ds_read_b64_tr_b16 a[162:163], v17 offset:4608
    v_mfma_f32_32x32x16_bf16 v[112:127], a[164:167], a[36:39], v[112:127]
    v_mul_f32 v45, v45, v77
    ds_read_b64_tr_b16 a[164:165], v18 offset:4096
    ds_read_b64_tr_b16 a[166:167], v18 offset:4608
    v_mfma_f32_32x32x16_bf16 v[128:143], a[168:171], a[36:39], v[128:143]
    v_cvt_pk_bf16_f32 v198, v44, v45
    ds_read_b64_tr_b16 a[168:169], v17 offset:22528
    ds_read_b64_tr_b16 a[170:171], v17 offset:23040
    v_mfma_f32_32x32x16_bf16 v[144:159], a[172:175], a[36:39], v[144:159]
    v_max_f32 v46, 0, v46
    buffer_load_dwordx4 v6, s[12:15], s62 offen offset:1024  lds
    ds_read_b64_tr_b16 a[172:173], v18 offset:22528
    ds_read_b64_tr_b16 a[174:175], v18 offset:23040
    s_waitcnt lgkmcnt(8)
    v_mfma_f32_32x32x16_bf16 v[96:111], a[144:147], a[40:43], v[96:111]
    v_max_f32 v47, 0, v47
    ds_read_b64_tr_b16 a[144:145], v17 offset:6144
    ds_read_b64_tr_b16 a[146:147], v17 offset:6656
    v_mfma_f32_32x32x16_bf16 v[112:127], a[148:151], a[40:43], v[112:127]
    v_mul_f32 v46, v46, v78
    ds_read_b64_tr_b16 a[148:149], v18 offset:6144
    ds_read_b64_tr_b16 a[150:151], v18 offset:6656
    v_mfma_f32_32x32x16_bf16 v[128:143], a[152:155], a[40:43], v[128:143]
    v_mul_f32 v47, v47, v79
    buffer_load_dwordx4 v7, s[12:15], s62 offen offset:2048  lds
    ds_read_b64_tr_b16 a[152:153], v17 offset:24576
    ds_read_b64_tr_b16 a[154:155], v17 offset:25088
    v_mfma_f32_32x32x16_bf16 v[144:159], a[156:159], a[40:43], v[144:159]
    v_cvt_pk_bf16_f32 v199, v46, v47
    ds_read_b64_tr_b16 a[156:157], v18 offset:24576
    ds_read_b64_tr_b16 a[158:159], v18 offset:25088
    s_waitcnt lgkmcnt(8)
    v_mfma_f32_32x32x16_bf16 v[96:111], a[160:163], a[44:47], v[96:111]
    s_add_u32 s63, s51, 9216
    buffer_store_dwordx4 v[196:199], v0, s[20:23], s63 offen sc1
    v_max_f32 v48, 0, v48
    ds_read_b64_tr_b16 a[160:161], v17 offset:8192
    ds_read_b64_tr_b16 a[162:163], v17 offset:8704
    v_mfma_f32_32x32x16_bf16 v[112:127], a[164:167], a[44:47], v[112:127]
    v_max_f32 v49, 0, v49
    buffer_load_dwordx4 v8, s[12:15], s62 offen offset:3072  lds
    ds_read_b64_tr_b16 a[164:165], v18 offset:8192
    ds_read_b64_tr_b16 a[166:167], v18 offset:8704
    v_mfma_f32_32x32x16_bf16 v[128:143], a[168:171], a[44:47], v[128:143]
    v_mul_f32 v48, v48, v80
    ds_read_b64_tr_b16 a[168:169], v17 offset:26624
    ds_read_b64_tr_b16 a[170:171], v17 offset:27136
    v_mfma_f32_32x32x16_bf16 v[144:159], a[172:175], a[44:47], v[144:159]
    v_mul_f32 v49, v49, v81
    ds_read_b64_tr_b16 a[172:173], v18 offset:26624
    ds_read_b64_tr_b16 a[174:175], v18 offset:27136
    s_waitcnt lgkmcnt(8)
    v_mfma_f32_32x32x16_bf16 v[96:111], a[144:147], a[48:51], v[96:111]
    v_cvt_pk_bf16_f32 v200, v48, v49
    s_add_u32 m0, s39, 40960
    s_add_u32 s62, s38, 589824
    buffer_load_dwordx4 v5, s[12:15], s62 offen offset:0  lds
    ds_read_b64_tr_b16 a[144:145], v17 offset:10240
    ds_read_b64_tr_b16 a[146:147], v17 offset:10752
    v_mfma_f32_32x32x16_bf16 v[112:127], a[148:151], a[48:51], v[112:127]
    v_max_f32 v50, 0, v50
    ds_read_b64_tr_b16 a[148:149], v18 offset:10240
    ds_read_b64_tr_b16 a[150:151], v18 offset:10752
    v_mfma_f32_32x32x16_bf16 v[128:143], a[152:155], a[48:51], v[128:143]
    v_max_f32 v51, 0, v51
    ds_read_b64_tr_b16 a[152:153], v17 offset:28672
    ds_read_b64_tr_b16 a[154:155], v17 offset:29184
    v_mfma_f32_32x32x16_bf16 v[144:159], a[156:159], a[48:51], v[144:159]
    v_mul_f32 v50, v50, v82
    buffer_load_dwordx4 v6, s[12:15], s62 offen offset:1024  lds
    ds_read_b64_tr_b16 a[156:157], v18 offset:28672
    ds_read_b64_tr_b16 a[158:159], v18 offset:29184
    s_waitcnt lgkmcnt(8)
    v_mfma_f32_32x32x16_bf16 v[96:111], a[160:163], a[52:55], v[96:111]
    v_mul_f32 v51, v51, v83
    ds_read_b64_tr_b16 a[160:161], v17 offset:12288
    ds_read_b64_tr_b16 a[162:163], v17 offset:12800
    v_mfma_f32_32x32x16_bf16 v[112:127], a[164:167], a[52:55], v[112:127]
    v_cvt_pk_bf16_f32 v201, v50, v51
    ds_read_b64_tr_b16 a[164:165], v18 offset:12288
    ds_read_b64_tr_b16 a[166:167], v18 offset:12800
    v_mfma_f32_32x32x16_bf16 v[128:143], a[168:171], a[52:55], v[128:143]
    v_max_f32 v52, 0, v52
    buffer_load_dwordx4 v7, s[12:15], s62 offen offset:2048  lds
    s_add_u32 s64, s81, 5760
    buffer_load_dword v253, v255, s[16:19], s64 offen
    s_add_u32 s64, s54, 1024
    buffer_load_dwordx4 a[212:215], v0, s[20:23], s64 offen sc1
    ds_read_b64_tr_b16 a[168:169], v17 offset:30720
    ds_read_b64_tr_b16 a[170:171], v17 offset:31232
    v_mfma_f32_32x32x16_bf16 v[144:159], a[172:175], a[52:55], v[144:159]
    v_max_f32 v53, 0, v53
    s_add_u32 s64, s81, 6912
    buffer_load_dword v253, v255, s[16:19], s64 offen
    ds_read_b64_tr_b16 a[172:173], v18 offset:30720
    ds_read_b64_tr_b16 a[174:175], v18 offset:31232
    s_waitcnt lgkmcnt(8)
    v_mfma_f32_32x32x16_bf16 v[96:111], a[144:147], a[56:59], v[96:111]
    v_mul_f32 v52, v52, v84
    ds_read_b64_tr_b16 a[144:145], v17 offset:14336
    ds_read_b64_tr_b16 a[146:147], v17 offset:14848
    v_mfma_f32_32x32x16_bf16 v[112:127], a[148:151], a[56:59], v[112:127]
    v_mul_f32 v53, v53, v85
    buffer_load_dwordx4 v8, s[12:15], s62 offen offset:3072  lds
    ds_read_b64_tr_b16 a[148:149], v18 offset:14336
    ds_read_b64_tr_b16 a[150:151], v18 offset:14848
    v_mfma_f32_32x32x16_bf16 v[128:143], a[152:155], a[56:59], v[128:143]
    v_cvt_pk_bf16_f32 v202, v52, v53
    ds_read_b64_tr_b16 a[152:153], v17 offset:32768
    ds_read_b64_tr_b16 a[154:155], v17 offset:33280
    v_mfma_f32_32x32x16_bf16 v[144:159], a[156:159], a[56:59], v[144:159]
    v_max_f32 v54, 0, v54
    ds_read_b64_tr_b16 a[156:157], v18 offset:32768
    ds_read_b64_tr_b16 a[158:159], v18 offset:33280
    s_waitcnt lgkmcnt(8)
    v_mfma_f32_32x32x16_bf16 v[96:111], a[160:163], a[60:63], v[96:111]
    v_max_f32 v55, 0, v55
    s_add_u32 m0, s39, 45056
    s_add_u32 s62, s38, 1179648
    buffer_load_dwordx4 v5, s[12:15], s62 offen offset:0  lds
    ds_read_b64_tr_b16 a[160:161], v17 offset:16384
    ds_read_b64_tr_b16 a[162:163], v17 offset:16896
    v_mfma_f32_32x32x16_bf16 v[112:127], a[164:167], a[60:63], v[112:127]
    v_mul_f32 v54, v54, v86
    ds_read_b64_tr_b16 a[164:165], v18 offset:16384
    ds_read_b64_tr_b16 a[166:167], v18 offset:16896
    v_mfma_f32_32x32x16_bf16 v[128:143], a[168:171], a[60:63], v[128:143]
    v_mul_f32 v55, v55, v87
    s_add_u32 s64, s54, 2048
    buffer_load_dwordx4 a[216:219], v0, s[20:23], s64 offen sc1
    ds_read_b64_tr_b16 a[168:169], v17 offset:34816
    ds_read_b64_tr_b16 a[170:171], v17 offset:35328
    v_mfma_f32_32x32x16_bf16 v[144:159], a[172:175], a[60:63], v[144:159]
    v_cvt_pk_bf16_f32 v203, v54, v55
    ds_read_b64_tr_b16 a[172:173], v18 offset:34816
    ds_read_b64_tr_b16 a[174:175], v18 offset:35328
    s_waitcnt lgkmcnt(8)
    v_mfma_f32_32x32x16_bf16 v[96:111], a[144:147], a[64:67], v[96:111]
    s_waitcnt vmcnt(36)
    s_barrier
    s_add_u32 s63, s51, 10240
    buffer_store_dwordx4 v[200:203], v0, s[20:23], s63 offen sc1
    v_max_f32 v56, 0, v56
    ds_read_b64_tr_b16 a[144:145], v19 offset:0
    ds_read_b64_tr_b16 a[146:147], v19 offset:512
    v_mfma_f32_32x32x16_bf16 v[112:127], a[148:151], a[64:67], v[112:127]
    v_max_f32 v57, 0, v57
    ds_read_b64_tr_b16 a[148:149], v20 offset:0
    ds_read_b64_tr_b16 a[150:151], v20 offset:512
    v_mfma_f32_32x32x16_bf16 v[128:143], a[152:155], a[64:67], v[128:143]
    v_mul_f32 v56, v56, v88
    ds_read_b64_tr_b16 a[152:153], v19 offset:18432
    ds_read_b64_tr_b16 a[154:155], v19 offset:18944
    v_mfma_f32_32x32x16_bf16 v[144:159], a[156:159], a[64:67], v[144:159]
    v_mul_f32 v57, v57, v89
    ds_read_b64_tr_b16 a[156:157], v20 offset:18432
    ds_read_b64_tr_b16 a[158:159], v20 offset:18944
    s_waitcnt lgkmcnt(8)
    v_mfma_f32_32x32x16_bf16 v[96:111], a[160:163], a[68:71], v[96:111]
    v_cvt_pk_bf16_f32 v204, v56, v57
    ds_read_b64_tr_b16 a[160:161], v19 offset:2048
    ds_read_b64_tr_b16 a[162:163], v19 offset:2560
    v_mfma_f32_32x32x16_bf16 v[112:127], a[164:167], a[68:71], v[112:127]
    v_max_f32 v58, 0, v58
    ds_read_b64_tr_b16 a[164:165], v20 offset:2048
    ds_read_b64_tr_b16 a[166:167], v20 offset:2560
    v_mfma_f32_32x32x16_bf16 v[128:143], a[168:171], a[68:71], v[128:143]
    v_max_f32 v59, 0, v59
    ds_read_b64_tr_b16 a[168:169], v19 offset:20480
    ds_read_b64_tr_b16 a[170:171], v19 offset:20992
    v_mfma_f32_32x32x16_bf16 v[144:159], a[172:175], a[68:71], v[144:159]
    s_barrier
    v_mul_f32 v58, v58, v90
    ds_read_b64_tr_b16 a[172:173], v20 offset:20480
    ds_read_b64_tr_b16 a[174:175], v20 offset:20992
    s_waitcnt lgkmcnt(8)
    v_mfma_f32_32x32x16_bf16 v[96:111], a[144:147], a[72:75], v[96:111]
    s_cbranch_vccnz W0_7
    buffer_load_dwordx4 v[248:251], off, s[20:23], s73 sc1
W0_7:
    v_mul_f32 v59, v59, v91
    s_add_u32 m0, s39, 73728
    s_add_u32 s62, s38, 2654208
    buffer_load_dwordx4 v5, s[12:15], s62 offen offset:0  lds
    ds_read_b64_tr_b16 a[144:145], v19 offset:4096
    ds_read_b64_tr_b16 a[146:147], v19 offset:4608
    v_mfma_f32_32x32x16_bf16 v[112:127], a[148:151], a[72:75], v[112:127]
    v_cvt_pk_bf16_f32 v205, v58, v59
    ds_read_b64_tr_b16 a[148:149], v20 offset:4096
    ds_read_b64_tr_b16 a[150:151], v20 offset:4608
    v_mfma_f32_32x32x16_bf16 v[128:143], a[152:155], a[72:75], v[128:143]
    v_max_f32 v60, 0, v60
    ds_read_b64_tr_b16 a[152:153], v19 offset:22528
    ds_read_b64_tr_b16 a[154:155], v19 offset:23040
    v_mfma_f32_32x32x16_bf16 v[144:159], a[156:159], a[72:75], v[144:159]
    v_max_f32 v61, 0, v61
    buffer_load_dwordx4 v6, s[12:15], s62 offen offset:1024  lds
    ds_read_b64_tr_b16 a[156:157], v20 offset:22528
    ds_read_b64_tr_b16 a[158:159], v20 offset:23040
    s_waitcnt lgkmcnt(8)
    v_mfma_f32_32x32x16_bf16 v[96:111], a[160:163], a[76:79], v[96:111]
    v_mul_f32 v60, v60, v92
    ds_read_b64_tr_b16 a[160:161], v19 offset:6144
    ds_read_b64_tr_b16 a[162:163], v19 offset:6656
    v_mfma_f32_32x32x16_bf16 v[112:127], a[164:167], a[76:79], v[112:127]
    v_mul_f32 v61, v61, v93
    ds_read_b64_tr_b16 a[164:165], v20 offset:6144
    ds_read_b64_tr_b16 a[166:167], v20 offset:6656
    v_mfma_f32_32x32x16_bf16 v[128:143], a[168:171], a[76:79], v[128:143]
    v_cvt_pk_bf16_f32 v206, v60, v61
    buffer_load_dwordx4 v7, s[12:15], s62 offen offset:2048  lds
    ds_read_b64_tr_b16 a[168:169], v19 offset:24576
    ds_read_b64_tr_b16 a[170:171], v19 offset:25088
    v_mfma_f32_32x32x16_bf16 v[144:159], a[172:175], a[76:79], v[144:159]
    v_max_f32 v62, 0, v62
    ds_read_b64_tr_b16 a[172:173], v20 offset:24576
    ds_read_b64_tr_b16 a[174:175], v20 offset:25088
    s_waitcnt lgkmcnt(8)
    v_mfma_f32_32x32x16_bf16 v[96:111], a[144:147], a[80:83], v[96:111]
    v_max_f32 v63, 0, v63
    ds_read_b64_tr_b16 a[144:145], v19 offset:8192
    ds_read_b64_tr_b16 a[146:147], v19 offset:8704
    v_mfma_f32_32x32x16_bf16 v[112:127], a[148:151], a[80:83], v[112:127]
    v_mul_f32 v62, v62, v94
    buffer_load_dwordx4 v8, s[12:15], s62 offen offset:3072  lds
    ds_read_b64_tr_b16 a[148:149], v20 offset:8192
    ds_read_b64_tr_b16 a[150:151], v20 offset:8704
    v_mfma_f32_32x32x16_bf16 v[128:143], a[152:155], a[80:83], v[128:143]
    v_mul_f32 v63, v63, v95
    ds_read_b64_tr_b16 a[152:153], v19 offset:26624
    ds_read_b64_tr_b16 a[154:155], v19 offset:27136
    v_mfma_f32_32x32x16_bf16 v[144:159], a[156:159], a[80:83], v[144:159]
    v_cvt_pk_bf16_f32 v207, v62, v63
    ds_read_b64_tr_b16 a[156:157], v20 offset:26624
    ds_read_b64_tr_b16 a[158:159], v20 offset:27136
    s_waitcnt lgkmcnt(8)
    v_mfma_f32_32x32x16_bf16 v[96:111], a[160:163], a[84:87], v[96:111]
    s_add_u32 s63, s51, 11264
    buffer_store_dwordx4 v[204:207], v0, s[20:23], s63 offen sc1
    s_add_u32 m0, s39, 77824
    s_add_u32 s62, s38, 3244032
    buffer_load_dwordx4 v5, s[12:15], s62 offen offset:0  lds
    ds_read_b64_tr_b16 a[160:161], v19 offset:10240
    ds_read_b64_tr_b16 a[162:163], v19 offset:10752
    v_mfma_f32_32x32x16_bf16 v[112:127], a[164:167], a[84:87], v[112:127]
    ds_read_b64_tr_b16 a[164:165], v20 offset:10240
    ds_read_b64_tr_b16 a[166:167], v20 offset:10752
    v_mfma_f32_32x32x16_bf16 v[128:143], a[168:171], a[84:87], v[128:143]
    ds_read_b64_tr_b16 a[168:169], v19 offset:28672
    ds_read_b64_tr_b16 a[170:171], v19 offset:29184
    v_mfma_f32_32x32x16_bf16 v[144:159], a[172:175], a[84:87], v[144:159]
    buffer_load_dwordx4 v6, s[12:15], s62 offen offset:1024  lds
    ds_read_b64_tr_b16 a[172:173], v20 offset:28672
    ds_read_b64_tr_b16 a[174:175], v20 offset:29184
    s_waitcnt lgkmcnt(8)
    v_mfma_f32_32x32x16_bf16 v[96:111], a[144:147], a[88:91], v[96:111]
    ds_read_b64_tr_b16 a[144:145], v19 offset:12288
    ds_read_b64_tr_b16 a[146:147], v19 offset:12800
    v_mfma_f32_32x32x16_bf16 v[112:127], a[148:151], a[88:91], v[112:127]
    ds_read_b64_tr_b16 a[148:149], v20 offset:12288
    ds_read_b64_tr_b16 a[150:151], v20 offset:12800
    v_mfma_f32_32x32x16_bf16 v[128:143], a[152:155], a[88:91], v[128:143]
    buffer_load_dwordx4 v7, s[12:15], s62 offen offset:2048  lds
    s_add_u32 s64, s81, 8064
    buffer_load_dword v253, v255, s[16:19], s64 offen
    s_add_u32 s64, s54, 3072
    buffer_load_dwordx4 a[220:223], v0, s[20:23], s64 offen sc1
    ds_read_b64_tr_b16 a[152:153], v19 offset:30720
    ds_read_b64_tr_b16 a[154:155], v19 offset:31232
    v_mfma_f32_32x32x16_bf16 v[144:159], a[156:159], a[88:91], v[144:159]
    s_add_u32 s64, s81, 9216
    buffer_load_dword v253, v255, s[16:19], s64 offen
    ds_read_b64_tr_b16 a[156:157], v20 offset:30720
    ds_read_b64_tr_b16 a[158:159], v20 offset:31232
    s_waitcnt lgkmcnt(8)
    v_mfma_f32_32x32x16_bf16 v[96:111], a[160:163], a[92:95], v[96:111]
    ds_read_b64_tr_b16 a[160:161], v19 offset:14336
    ds_read_b64_tr_b16 a[162:163], v19 offset:14848
    v_mfma_f32_32x32x16_bf16 v[112:127], a[164:167], a[92:95], v[112:127]
    buffer_load_dwordx4 v8, s[12:15], s62 offen offset:3072  lds
    ds_read_b64_tr_b16 a[164:165], v20 offset:14336
    ds_read_b64_tr_b16 a[166:167], v20 offset:14848
    v_mfma_f32_32x32x16_bf16 v[128:143], a[168:171], a[92:95], v[128:143]
    ds_read_b64_tr_b16 a[168:169], v19 offset:32768
    ds_read_b64_tr_b16 a[170:171], v19 offset:33280
    v_mfma_f32_32x32x16_bf16 v[144:159], a[172:175], a[92:95], v[144:159]
    ds_read_b64_tr_b16 a[172:173], v20 offset:32768
    ds_read_b64_tr_b16 a[174:175], v20 offset:33280
    s_waitcnt lgkmcnt(8)
    v_mfma_f32_32x32x16_bf16 v[96:111], a[144:147], a[96:99], v[96:111]
    s_add_u32 m0, s39, 81920
    s_add_u32 s62, s38, 3833856
    buffer_load_dwordx4 v5, s[12:15], s62 offen offset:0  lds
    ds_read_b64_tr_b16 a[144:145], v19 offset:16384
    ds_read_b64_tr_b16 a[146:147], v19 offset:16896
    v_mfma_f32_32x32x16_bf16 v[112:127], a[148:151], a[96:99], v[112:127]
    ds_read_b64_tr_b16 a[148:149], v20 offset:16384
    ds_read_b64_tr_b16 a[150:151], v20 offset:16896
    v_mfma_f32_32x32x16_bf16 v[128:143], a[152:155], a[96:99], v[128:143]
    ds_read_b64_tr_b16 a[152:153], v19 offset:34816
    ds_read_b64_tr_b16 a[154:155], v19 offset:35328
    v_mfma_f32_32x32x16_bf16 v[144:159], a[156:159], a[96:99], v[144:159]
    ds_read_b64_tr_b16 a[156:157], v20 offset:34816
    ds_read_b64_tr_b16 a[158:159], v20 offset:35328
    s_waitcnt lgkmcnt(8)
    v_mfma_f32_32x32x16_bf16 v[96:111], a[160:163], a[100:103], v[96:111]
    s_waitcnt vmcnt(35)
    s_cbranch_vccnz W0_8
    s_waitcnt vmcnt(13)
    s_add_u32 s78, s72, 2
    v_subrev_u32 v248, s78, v248
    v_subrev_u32 v249, s78, v249
    v_subrev_u32 v250, s78, v250
    v_subrev_u32 v251, s78, v251
    v_or_b32 v248, v248, v249
    v_or_b32 v250, v250, v251
    v_or_b32 v248, v248, v250
    v_cmp_gt_u32 s[82:83], 8, v248
    s_nop 1
    s_cmp_eq_u64 s[82:83], -1
    s_cbranch_scc0 SLOW2
OK2:
W0_8:
    s_barrier
    ds_read_b64_tr_b16 a[160:161], v13 offset:0
    ds_read_b64_tr_b16 a[162:163], v13 offset:512
    v_mfma_f32_32x32x16_bf16 v[112:127], a[164:167], a[100:103], v[112:127]
    ds_read_b64_tr_b16 a[164:165], v14 offset:0
    ds_read_b64_tr_b16 a[166:167], v14 offset:512
    v_mfma_f32_32x32x16_bf16 v[128:143], a[168:171], a[100:103], v[128:143]
    ds_read_b64_tr_b16 a[168:169], v13 offset:18432
    ds_read_b64_tr_b16 a[170:171], v13 offset:18944
    v_mfma_f32_32x32x16_bf16 v[144:159], a[172:175], a[100:103], v[144:159]
    ds_read_b64_tr_b16 a[172:173], v14 offset:18432
    ds_read_b64_tr_b16 a[174:175], v14 offset:18944
    s_waitcnt lgkmcnt(8)
    v_mfma_f32_32x32x16_bf16 v[96:111], a[144:147], a[104:107], v[96:111]
    ds_read_b64_tr_b16 a[144:145], v13 offset:2048
    ds_read_b64_tr_b16 a[146:147], v13 offset:2560
    v_mfma_f32_32x32x16_bf16 v[112:127], a[148:151], a[104:107], v[112:127]
    ds_read_b64_tr_b16 a[148:149], v14 offset:2048
    ds_read_b64_tr_b16 a[150:151], v14 offset:2560
    v_mfma_f32_32x32x16_bf16 v[128:143], a[152:155], a[104:107], v[128:143]
    ds_read_b64_tr_b16 a[152:153], v13 offset:20480
    ds_read_b64_tr_b16 a[154:155], v13 offset:20992
    v_mfma_f32_32x32x16_bf16 v[144:159], a[156:159], a[104:107], v[144:159]
    s_barrier
    ds_read_b64_tr_b16 a[156:157], v14 offset:20480
    ds_read_b64_tr_b16 a[158:159], v14 offset:20992
    s_waitcnt lgkmcnt(8)
    v_mfma_f32_32x32x16_bf16 v[96:111], a[160:163], a[108:111], v[96:111]
    s_add_u32 m0, s40, 110592
    s_add_u32 s62, s49, 1024
    buffer_load_dwordx4 v9, s[16:19], s62 offen  lds
    ds_read_b64_tr_b16 a[160:161], v13 offset:4096
    ds_read_b64_tr_b16 a[162:163], v13 offset:4608
    v_mfma_f32_32x32x16_bf16 v[112:127], a[164:167], a[108:111], v[112:127]
    ds_read_b64_tr_b16 a[164:165], v14 offset:4096
    ds_read_b64_tr_b16 a[166:167], v14 offset:4608
    v_mfma_f32_32x32x16_bf16 v[128:143], a[168:171], a[108:111], v[128:143]
    s_add_u32 m0, s40, 114688
    s_add_u32 s62, s49, 37888
    buffer_load_dwordx4 v9, s[16:19], s62 offen  lds
    ds_read_b64_tr_b16 a[168:169], v13 offset:22528
    ds_read_b64_tr_b16 a[170:171], v13 offset:23040
    v_mfma_f32_32x32x16_bf16 v[144:159], a[172:175], a[108:111], v[144:159]
    ds_read_b64_tr_b16 a[172:173], v14 offset:22528
    ds_read_b64_tr_b16 a[174:175], v14 offset:23040
    s_waitcnt lgkmcnt(8)
    v_mfma_f32_32x32x16_bf16 v[96:111], a[144:147], a[112:115], v[96:111]
    s_add_u32 m0, s40, 118784
    s_add_u32 s62, s49, 74752
    buffer_load_dwordx4 v9, s[16:19], s62 offen  lds
    ds_read_b64_tr_b16 a[144:145], v13 offset:6144
    ds_read_b64_tr_b16 a[146:147], v13 offset:6656
    v_mfma_f32_32x32x16_bf16 v[112:127], a[148:151], a[112:115], v[112:127]
    ds_read_b64_tr_b16 a[148:149], v14 offset:6144
    ds_read_b64_tr_b16 a[150:151], v14 offset:6656
    v_mfma_f32_32x32x16_bf16 v[128:143], a[152:155], a[112:115], v[128:143]
    s_add_u32 m0, s40, 122880
    s_add_u32 s62, s49, 111616
    buffer_load_dwordx4 v9, s[16:19], s62 offen  lds
    ds_read_b64_tr_b16 a[152:153], v13 offset:24576
    ds_read_b64_tr_b16 a[154:155], v13 offset:25088
    v_mfma_f32_32x32x16_bf16 v[144:159], a[156:159], a[112:115], v[144:159]
    ds_read_b64_tr_b16 a[156:157], v14 offset:24576
    ds_read_b64_tr_b16 a[158:159], v14 offset:25088
    s_waitcnt lgkmcnt(8)
    v_mfma_f32_32x32x16_bf16 v[96:111], a[160:163], a[116:119], v[96:111]
    s_add_u32 m0, s40, 126976
    s_add_u32 s62, s49, 148480
    buffer_load_dwordx4 v9, s[16:19], s62 offen  lds
    ds_read_b64_tr_b16 a[160:161], v13 offset:8192
    ds_read_b64_tr_b16 a[162:163], v13 offset:8704
    v_mfma_f32_32x32x16_bf16 v[112:127], a[164:167], a[116:119], v[112:127]
    ds_read_b64_tr_b16 a[164:165], v14 offset:8192
    ds_read_b64_tr_b16 a[166:167], v14 offset:8704
    v_mfma_f32_32x32x16_bf16 v[128:143], a[168:171], a[116:119], v[128:143]
    s_add_u32 m0, s40, 131072
    s_add_u32 s62, s49, 185344
    buffer_load_dwordx4 v9, s[16:19], s62 offen  lds
    ds_read_b64_tr_b16 a[168:169], v13 offset:26624
    ds_read_b64_tr_b16 a[170:171], v13 offset:27136
    v_mfma_f32_32x32x16_bf16 v[144:159], a[172:175], a[116:119], v[144:159]
    ds_read_b64_tr_b16 a[172:173], v14 offset:26624
    ds_read_b64_tr_b16 a[174:175], v14 offset:27136
    s_waitcnt lgkmcnt(8)
    v_mfma_f32_32x32x16_bf16 v[96:111], a[144:147], a[120:123], v[96:111]
    s_add_u32 m0, s40, 135168
    s_add_u32 s62, s49, 222208
    buffer_load_dwordx4 v9, s[16:19], s62 offen  lds
    ds_read_b64_tr_b16 a[144:145], v13 offset:10240
    ds_read_b64_tr_b16 a[146:147], v13 offset:10752
    v_mfma_f32_32x32x16_bf16 v[112:127], a[148:151], a[120:123], v[112:127]
    ds_read_b64_tr_b16 a[148:149], v14 offset:10240
    ds_read_b64_tr_b16 a[150:151], v14 offset:10752
    v_mfma_f32_32x32x16_bf16 v[128:143], a[152:155], a[120:123], v[128:143]
    s_add_u32 m0, s40, 139264
    s_add_u32 s62, s49, 259072
    buffer_load_dwordx4 v9, s[16:19], s62 offen  lds
    ds_read_b64_tr_b16 a[152:153], v13 offset:28672
    ds_read_b64_tr_b16 a[154:155], v13 offset:29184
    v_mfma_f32_32x32x16_bf16 v[144:159], a[156:159], a[120:123], v[144:159]
    ds_read_b64_tr_b16 a[156:157], v14 offset:28672
    ds_read_b64_tr_b16 a[158:159], v14 offset:29184
    s_waitcnt lgkmcnt(8)
    v_mfma_f32_32x32x16_bf16 v[96:111], a[160:163], a[124:127], v[96:111]
    s_add_u32 m0, s40, 143360
    s_add_u32 s62, s50, 1024
    buffer_load_dwordx4 v9, s[16:19], s62 offen  lds
    ds_read_b64_tr_b16 a[160:161], v13 offset:12288
    ds_read_b64_tr_b16 a[162:163], v13 offset:12800
    v_mfma_f32_32x32x16_bf16 v[112:127], a[164:167], a[124:127], v[112:127]
    ds_read_b64_tr_b16 a[164:165], v14 offset:12288
    ds_read_b64_tr_b16 a[166:167], v14 offset:12800
    v_mfma_f32_32x32x16_bf16 v[128:143], a[168:171], a[124:127], v[128:143]
    s_add_u32 s64, s52, 4096
    buffer_load_dwordx4 a[224:227], v0, s[20:23], s64 offen sc1
    ds_read_b64_tr_b16 a[168:169], v13 offset:30720
    ds_read_b64_tr_b16 a[170:171], v13 offset:31232
    v_mfma_f32_32x32x16_bf16 v[144:159], a[172:175], a[124:127], v[144:159]
    ds_read_b64_tr_b16 a[172:173], v14 offset:30720
    ds_read_b64_tr_b16 a[174:175], v14 offset:31232
    s_waitcnt lgkmcnt(8)
    v_mfma_f32_32x32x16_bf16 v[96:111], a[144:147], a[128:131], v[96:111]
    ds_read_b64_tr_b16 a[144:145], v13 offset:14336
    ds_read_b64_tr_b16 a[146:147], v13 offset:14848
    v_mfma_f32_32x32x16_bf16 v[112:127], a[148:151], a[128:131], v[112:127]
    ds_read_b64_tr_b16 a[148:149], v14 offset:14336
    ds_read_b64_tr_b16 a[150:151], v14 offset:14848
    v_mfma_f32_32x32x16_bf16 v[128:143], a[152:155], a[128:131], v[128:143]
    ds_read_b64_tr_b16 a[152:153], v13 offset:32768
    ds_read_b64_tr_b16 a[154:155], v13 offset:33280
    v_mfma_f32_32x32x16_bf16 v[144:159], a[156:159], a[128:131], v[144:159]
    ds_read_b64_tr_b16 a[156:157], v14 offset:32768
    ds_read_b64_tr_b16 a[158:159], v14 offset:33280
    s_waitcnt lgkmcnt(8)
    v_mfma_f32_32x32x16_bf16 v[96:111], a[160:163], a[132:135], v[96:111]
    ds_read_b64_tr_b16 a[160:161], v13 offset:16384
    ds_read_b64_tr_b16 a[162:163], v13 offset:16896
    v_mfma_f32_32x32x16_bf16 v[112:127], a[164:167], a[132:135], v[112:127]
    ds_read_b64_tr_b16 a[164:165], v14 offset:16384
    ds_read_b64_tr_b16 a[166:167], v14 offset:16896
    v_mfma_f32_32x32x16_bf16 v[128:143], a[168:171], a[132:135], v[128:143]
    s_add_u32 s64, s52, 5120
    buffer_load_dwordx4 a[228:231], v0, s[20:23], s64 offen sc1
    ds_read_b64_tr_b16 a[168:169], v13 offset:34816
    ds_read_b64_tr_b16 a[170:171], v13 offset:35328
    v_mfma_f32_32x32x16_bf16 v[144:159], a[172:175], a[132:135], v[144:159]
    ds_read_b64_tr_b16 a[172:173], v14 offset:34816
    ds_read_b64_tr_b16 a[174:175], v14 offset:35328
    s_waitcnt lgkmcnt(8)
    v_mfma_f32_32x32x16_bf16 v[96:111], a[144:147], a[136:139], v[96:111]
    s_waitcnt vmcnt(26)
    s_waitcnt vmcnt(19)
    s_barrier
    s_cbranch_vccnz W0_9
    s_add_u32 s78, s72, 3
    v_mov_b32 v252, s78
    buffer_store_dword v252, off, s[20:23], s76 sc1
W0_9:
    ds_read_b64_tr_b16 a[144:145], v21 offset:0
    ds_read_b64_tr_b16 a[146:147], v21 offset:256
    v_mfma_f32_32x32x16_bf16 v[112:127], a[148:151], a[136:139], v[112:127]
    ds_read_b64_tr_b16 a[148:149], v21 offset:18432
    ds_read_b64_tr_b16 a[150:151], v21 offset:18688
    v_mfma_f32_32x32x16_bf16 v[128:143], a[152:155], a[136:139], v[128:143]
    ds_read_b64_tr_b16 a[152:153], v21 offset:1024
    ds_read_b64_tr_b16 a[154:155], v21 offset:1280
    v_mfma_f32_32x32x16_bf16 v[144:159], a[156:159], a[136:139], v[144:159]
    ds_read_b64_tr_b16 a[156:157], v21 offset:19456
    ds_read_b64_tr_b16 a[158:159], v21 offset:19712
    s_waitcnt lgkmcnt(8)
    v_mfma_f32_32x32x16_bf16 v[96:111], a[160:163], a[140:143], v[96:111]
    ds_read_b64_tr_b16 a[160:161], v21 offset:2048
    ds_read_b64_tr_b16 a[162:163], v21 offset:2304
    v_mfma_f32_32x32x16_bf16 v[112:127], a[164:167], a[140:143], v[112:127]
    ds_read_b64_tr_b16 a[164:165], v21 offset:20480
    ds_read_b64_tr_b16 a[166:167], v21 offset:20736
    v_mfma_f32_32x32x16_bf16 v[128:143], a[168:171], a[140:143], v[128:143]
    ds_read_b64_tr_b16 a[168:169], v21 offset:3072
    ds_read_b64_tr_b16 a[170:171], v21 offset:3328
    v_mfma_f32_32x32x16_bf16 v[144:159], a[172:175], a[140:143], v[144:159]
    s_barrier
    ds_read_b64_tr_b16 a[172:173], v21 offset:21504
    ds_read_b64_tr_b16 a[174:175], v21 offset:21760
    s_waitcnt lgkmcnt(8)
    v_mfma_f32_32x32x16_bf16 v[32:47], a[144:147], a[0:3], 0
    s_add_u32 m0, s40, 0
    s_add_u32 s62, s41, 0
    s_add_u32 s62, s62, s3
    buffer_load_dwordx4 v9, s[16:19], s62 offen  lds
    ds_read_b64_tr_b16 a[144:145], v21 offset:4096
    ds_read_b64_tr_b16 a[146:147], v21 offset:4352
    v_mfma_f32_32x32x16_bf16 v[64:79], a[148:151], a[0:3], 0
    ds_read_b64_tr_b16 a[148:149], v21 offset:22528
    ds_read_b64_tr_b16 a[150:151], v21 offset:22784
    v_mfma_f32_32x32x16_bf16 v[32:47], a[152:155], a[4:7], v[32:47]
    s_add_u32 m0, s40, 4096
    s_add_u32 s62, s41, 36864
    s_add_u32 s62, s62, s3
    buffer_load_dwordx4 v9, s[16:19], s62 offen  lds
    ds_read_b64_tr_b16 a[152:153], v21 offset:5120
    ds_read_b64_tr_b16 a[154:155], v21 offset:5376
    v_mfma_f32_32x32x16_bf16 v[64:79], a[156:159], a[4:7], v[64:79]
    ds_read_b64_tr_b16 a[156:157], v21 offset:23552
    ds_read_b64_tr_b16 a[158:159], v21 offset:23808
    s_waitcnt lgkmcnt(8)
    v_mfma_f32_32x32x16_bf16 v[32:47], a[160:163], a[8:11], v[32:47]
    v_max_f32 v96, 0, v96
    s_add_u32 m0, s40, 8192
    s_add_u32 s62, s41, 73728
    s_add_u32 s62, s62, s3
    buffer_load_dwordx4 v9, s[16:19], s62 offen  lds
    ds_read_b64_tr_b16 a[160:161], v21 offset:6144
    ds_read_b64_tr_b16 a[162:163], v21 offset:6400
    v_mfma_f32_32x32x16_bf16 v[64:79], a[164:167], a[8:11], v[64:79]
    v_max_f32 v97, 0, v97
    ds_read_b64_tr_b16 a[164:165], v21 offset:24576
    ds_read_b64_tr_b16 a[166:167], v21 offset:24832
    v_mfma_f32_32x32x16_bf16 v[32:47], a[168:171], a[12:15], v[32:47]
    v_mul_f32 v96, v96, v128
    s_add_u32 m0, s40, 12288
    s_add_u32 s62, s41, 110592
    s_add_u32 s62, s62, s3
    buffer_load_dwordx4 v9, s[16:19], s62 offen  lds
    ds_read_b64_tr_b16 a[168:169], v21 offset:7168
    ds_read_b64_tr_b16 a[170:171], v21 offset:7424
    v_mfma_f32_32x32x16_bf16 v[64:79], a[172:175], a[12:15], v[64:79]
    v_mul_f32 v97, v97, v129
    ds_read_b64_tr_b16 a[172:173], v21 offset:25600
    ds_read_b64_tr_b16 a[174:175], v21 offset:25856
    s_waitcnt lgkmcnt(8)
    v_mfma_f32_32x32x16_bf16 v[32:47], a[144:147], a[16:19], v[32:47]
    v_cvt_pk_bf16_f32 v208, v96, v97
    s_add_u32 m0, s40, 16384
    s_add_u32 s62, s41, 147456
    s_add_u32 s62, s62, s3
    buffer_load_dwordx4 v9, s[16:19], s62 offen  lds
    ds_read_b64_tr_b16 a[144:145], v21 offset:8192
    ds_read_b64_tr_b16 a[146:147], v21 offset:8448
    v_mfma_f32_32x32x16_bf16 v[64:79], a[148:151], a[16:19], v[64:79]
    v_max_f32 v98, 0, v98
    ds_read_b64_tr_b16 a[148:149], v21 offset:26624
    ds_read_b64_tr_b16 a[150:151], v21 offset:26880
    v_mfma_f32_32x32x16_bf16 v[32:47], a[152:155], a[20:23], v[32:47]
    v_max_f32 v99, 0, v99
    s_add_u32 m0, s40, 20480
    s_add_u32 s62, s41, 184320
    s_add_u32 s62, s62, s3
    buffer_load_dwordx4 v9, s[16:19], s62 offen  lds
    ds_read_b64_tr_b16 a[152:153], v21 offset:9216
    ds_read_b64_tr_b16 a[154:155], v21 offset:9472
    v_mfma_f32_32x32x16_bf16 v[64:79], a[156:159], a[20:23], v[64:79]
    v_mul_f32 v98, v98, v130
    ds_read_b64_tr_b16 a[156:157], v21 offset:27648
    ds_read_b64_tr_b16 a[158:159], v21 offset:27904
    s_waitcnt lgkmcnt(8)
    v_mfma_f32_32x32x16_bf16 v[32:47], a[160:163], a[24:27], v[32:47]
    v_mul_f32 v99, v99, v131
    s_add_u32 m0, s40, 24576
    s_add_u32 s62, s41, 221184
    s_add_u32 s62, s62, s3
    buffer_load_dwordx4 v9, s[16:19], s62 offen  lds
    ds_read_b64_tr_b16 a[160:161], v21 offset:10240
    ds_read_b64_tr_b16 a[162:163], v21 offset:10496
    v_mfma_f32_32x32x16_bf16 v[64:79], a[164:167], a[24:27], v[64:79]
    v_cvt_pk_bf16_f32 v209, v98, v99
    ds_read_b64_tr_b16 a[164:165], v21 offset:28672
    ds_read_b64_tr_b16 a[166:167], v21 offset:28928
    v_mfma_f32_32x32x16_bf16 v[32:47], a[168:171], a[28:31], v[32:47]
    v_max_f32 v100, 0, v100
    s_add_u32 m0, s40, 28672
    s_add_u32 s62, s41, 258048
    s_add_u32 s62, s62, s3
    buffer_load_dwordx4 v9, s[16:19], s62 offen  lds
    ds_read_b64_tr_b16 a[168:169], v21 offset:11264
    ds_read_b64_tr_b16 a[170:171], v21 offset:11520
    v_mfma_f32_32x32x16_bf16 v[64:79], a[172:175], a[28:31], v[64:79]
    v_max_f32 v101, 0, v101
    ds_read_b64_tr_b16 a[172:173], v21 offset:29696
    ds_read_b64_tr_b16 a[174:175], v21 offset:29952
    s_waitcnt lgkmcnt(8)
    v_mfma_f32_32x32x16_bf16 v[32:47], a[144:147], a[32:35], v[32:47]
    v_mul_f32 v100, v100, v132
    s_add_u32 m0, s40, 32768
    s_add_u32 s62, s45, 0
    s_add_u32 s62, s62, s3
    buffer_load_dwordx4 v9, s[16:19], s62 offen  lds
    ds_read_b64_tr_b16 a[144:145], v21 offset:12288
    ds_read_b64_tr_b16 a[146:147], v21 offset:12544
    v_mfma_f32_32x32x16_bf16 v[64:79], a[148:151], a[32:35], v[64:79]
    v_mul_f32 v101, v101, v133
    ds_read_b64_tr_b16 a[148:149], v21 offset:30720
    ds_read_b64_tr_b16 a[150:151], v21 offset:30976
    v_mfma_f32_32x32x16_bf16 v[32:47], a[152:155], a[36:39], v[32:47]
    v_cvt_pk_bf16_f32 v210, v100, v101
    s_add_u32 s64, s52, 6144
    buffer_load_dwordx4 a[232:235], v0, s[20:23], s64 offen sc1
    ds_read_b64_tr_b16 a[152:153], v21 offset:13312
    ds_read_b64_tr_b16 a[154:155], v21 offset:13568
    v_mfma_f32_32x32x16_bf16 v[64:79], a[156:159], a[36:39], v[64:79]
    v_max_f32 v102, 0, v102
    ds_read_b64_tr_b16 a[156:157], v21 offset:31744
    ds_read_b64_tr_b16 a[158:159], v21 offset:32000
    s_waitcnt lgkmcnt(8)
    v_mfma_f32_32x32x16_bf16 v[32:47], a[160:163], a[40:43], v[32:47]
    v_max_f32 v103, 0, v103
    ds_read_b64_tr_b16 a[160:161], v21 offset:14336
    ds_read_b64_tr_b16 a[162:163], v21 offset:14592
    v_mfma_f32_32x32x16_bf16 v[64:79], a[164:167], a[40:43], v[64:79]
    v_mul_f32 v102, v102, v134
    ds_read_b64_tr_b16 a[164:165], v21 offset:32768
    ds_read_b64_tr_b16 a[166:167], v21 offset:33024
    v_mfma_f32_32x32x16_bf16 v[32:47], a[168:171], a[44:47], v[32:47]
    v_mul_f32 v103, v103, v135
    ds_read_b64_tr_b16 a[168:169], v21 offset:15360
    ds_read_b64_tr_b16 a[170:171], v21 offset:15616
    v_mfma_f32_32x32x16_bf16 v[64:79], a[172:175], a[44:47], v[64:79]
    v_cvt_pk_bf16_f32 v211, v102, v103
    ds_read_b64_tr_b16 a[172:173], v21 offset:33792
    ds_read_b64_tr_b16 a[174:175], v21 offset:34048
    s_waitcnt lgkmcnt(8)
    v_mfma_f32_32x32x16_bf16 v[32:47], a[144:147], a[48:51], v[32:47]
    s_add_u32 s63, s51, 12288
    buffer_store_dwordx4 v[208:211], v0, s[20:23], s63 offen sc1
    v_max_f32 v104, 0, v104
    ds_read_b64_tr_b16 a[144:145], v21 offset:16384
    ds_read_b64_tr_b16 a[146:147], v21 offset:16640
    v_mfma_f32_32x32x16_bf16 v[64:79], a[148:151], a[48:51], v[64:79]
    v_max_f32 v105, 0, v105
    ds_read_b64_tr_b16 a[148:149], v21 offset:34816
    ds_read_b64_tr_b16 a[150:151], v21 offset:35072
    v_mfma_f32_32x32x16_bf16 v[32:47], a[152:155], a[52:55], v[32:47]
    v_mul_f32 v104, v104, v136
    s_add_u32 s64, s52, 7168
    buffer_load_dwordx4 a[236:239], v0, s[20:23], s64 offen sc1
    ds_read_b64_tr_b16 a[152:153], v21 offset:17408
    ds_read_b64_tr_b16 a[154:155], v21 offset:17664
    v_mfma_f32_32x32x16_bf16 v[64:79], a[156:159], a[52:55], v[64:79]
    v_mul_f32 v105, v105, v137
    ds_read_b64_tr_b16 a[156:157], v21 offset:35840
    ds_read_b64_tr_b16 a[158:159], v21 offset:36096
    s_waitcnt lgkmcnt(8)
    v_mfma_f32_32x32x16_bf16 v[32:47], a[160:163], a[56:59], v[32:47]
    s_waitcnt vmcnt(23)
    s_barrier
    v_cvt_pk_bf16_f32 v212, v104, v105
    ds_read_b64_tr_b16 a[160:161], v22 offset:0
    ds_read_b64_tr_b16 a[162:163], v22 offset:256
    v_mfma_f32_32x32x16_bf16 v[64:79], a[164:167], a[56:59], v[64:79]
    v_max_f32 v106, 0, v106
    ds_read_b64_tr_b16 a[164:165], v22 offset:18432
    ds_read_b64_tr_b16 a[166:167], v22 offset:18688
    v_mfma_f32_32x32x16_bf16 v[32:47], a[168:171], a[60:63], v[32:47]
    v_max_f32 v107, 0, v107
    ds_read_b64_tr_b16 a[168:169], v22 offset:1024
    ds_read_b64_tr_b16 a[170:171], v22 offset:1280
    v_mfma_f32_32x32x16_bf16 v[64:79], a[172:175], a[60:63], v[64:79]
    v_mul_f32 v106, v106, v138
    ds_read_b64_tr_b16 a[172:173], v22 offset:19456
    ds_read_b64_tr_b16 a[174:175], v22 offset:19712
    s_waitcnt lgkmcnt(8)
    v_mfma_f32_32x32x16_bf16 v[32:47], a[144:147], a[64:67], v[32:47]
    v_mul_f32 v107, v107, v139
    ds_read_b64_tr_b16 a[144:145], v22 offset:2048
    ds_read_b64_tr_b16 a[146:147], v22 offset:2304
    v_mfma_f32_32x32x16_bf16 v[64:79], a[148:151], a[64:67], v[64:79]
    v_cvt_pk_bf16_f32 v213, v106, v107
    ds_read_b64_tr_b16 a[148:149], v22 offset:20480
    ds_read_b64_tr_b16 a[150:151], v22 offset:20736
    v_mfma_f32_32x32x16_bf16 v[32:47], a[152:155], a[68:71], v[32:47]
    v_max_f32 v108, 0, v108
    ds_read_b64_tr_b16 a[152:153], v22 offset:3072
    ds_read_b64_tr_b16 a[154:155], v22 offset:3328
    v_mfma_f32_32x32x16_bf16 v[64:79], a[156:159], a[68:71], v[64:79]
    s_barrier
    v_max_f32 v109, 0, v109
    ds_read_b64_tr_b16 a[156:157], v22 offset:21504
    ds_read_b64_tr_b16 a[158:159], v22 offset:21760
    s_waitcnt lgkmcnt(8)
    v_mfma_f32_32x32x16_bf16 v[32:47], a[160:163], a[72:75], v[32:47]
    v_mul_f32 v108, v108, v140
    s_add_u32 m0, s40, 36864
    s_add_u32 s62, s41, 0
    buffer_load_dwordx4 v9, s[16:19], s62 offen  lds
    ds_read_b64_tr_b16 a[160:161], v22 offset:4096
    ds_read_b64_tr_b16 a[162:163], v22 offset:4352
    v_mfma_f32_32x32x16_bf16 v[64:79], a[164:167], a[72:75], v[64:79]
    v_mul_f32 v109, v109, v141
    ds_read_b64_tr_b16 a[164:165], v22 offset:22528
    ds_read_b64_tr_b16 a[166:167], v22 offset:22784
    v_mfma_f32_32x32x16_bf16 v[32:47], a[168:171], a[76:79], v[32:47]
    v_cvt_pk_bf16_f32 v214, v108, v109
    s_add_u32 m0, s40, 40960
    s_add_u32 s62, s41, 36864
    buffer_load_dwordx4 v9, s[16:19], s62 offen  lds
    ds_read_b64_tr_b16 a[168:169], v22 offset:5120
    ds_read_b64_tr_b16 a[170:171], v22 offset:5376
    v_mfma_f32_32x32x16_bf16 v[64:79], a[172:175], a[76:79], v[64:79]
    v_max_f32 v110, 0, v110
    ds_read_b64_tr_b16 a[172:173], v22 offset:23552
    ds_read_b64_tr_b16 a[174:175], v22 offset:23808
    s_waitcnt lgkmcnt(8)
    v_mfma_f32_32x32x16_bf16 v[32:47], a[144:147], a[80:83], v[32:47]
    v_max_f32 v111, 0, v111
    s_add_u32 m0, s40, 45056
    s_add_u32 s62, s41, 73728
    buffer_load_dwordx4 v9, s[16:19], s62 offen  lds
    ds_read_b64_tr_b16 a[144:145], v22 offset:6144
    ds_read_b64_tr_b16 a[146:147], v22 offset:6400
    v_mfma_f32_32x32x16_bf16 v[64:79], a[148:151], a[80:83], v[64:79]
    v_mul_f32 v110, v110, v142
    ds_read_b64_tr_b16 a[148:149], v22 offset:24576
    ds_read_b64_tr_b16 a[150:151], v22 offset:24832
    v_mfma_f32_32x32x16_bf16 v[32:47], a[152:155], a[84:87], v[32:47]
    v_mul_f32 v111, v111, v143
    s_add_u32 m0, s40, 49152
    s_add_u32 s62, s41, 110592
    buffer_load_dwordx4 v9, s[16:19], s62 offen  lds
    ds_read_b64_tr_b16 a[152:153], v22 offset:7168
    ds_read_b64_tr_b16 a[154:155], v22 offset:7424
    v_mfma_f32_32x32x16_bf16 v[64:79], a[156:159], a[84:87], v[64:79]
    v_cvt_pk_bf16_f32 v215, v110, v111
    ds_read_b64_tr_b16 a[156:157], v22 offset:25600
    ds_read_b64_tr_b16 a[158:159], v22 offset:25856
    s_waitcnt lgkmcnt(8)
    v_mfma_f32_32x32x16_bf16 v[32:47], a[160:163], a[88:91], v[32:47]
    s_add_u32 s63, s51, 13312
    buffer_store_dwordx4 v[212:215], v0, s[20:23], s63 offen sc1
    v_max_f32 v112, 0, v112
    s_add_u32 m0, s40, 53248
    s_add_u32 s62, s41, 147456
    buffer_load_dwordx4 v9, s[16:19], s62 offen  lds
    ds_read_b64_tr_b16 a[160:161], v22 offset:8192
    ds_read_b64_tr_b16 a[162:163], v22 offset:8448
    v_mfma_f32_32x32x16_bf16 v[64:79], a[164:167], a[88:91], v[64:79]
    v_max_f32 v113, 0, v113
    ds_read_b64_tr_b16 a[164:165], v22 offset:26624
    ds_read_b64_tr_b16 a[166:167], v22 offset:26880
    v_mfma_f32_32x32x16_bf16 v[32:47], a[168:171], a[92:95], v[32:47]
    v_mul_f32 v112, v112, v144
    s_add_u32 m0, s40, 57344
    s_add_u32 s62, s41, 184320
    buffer_load_dwordx4 v9, s[16:19], s62 offen  lds
    ds_read_b64_tr_b16 a[168:169], v22 offset:9216
    ds_read_b64_tr_b16 a[170:171], v22 offset:9472
    v_mfma_f32_32x32x16_bf16 v[64:79], a[172:175], a[92:95], v[64:79]
    v_mul_f32 v113, v113, v145
    ds_read_b64_tr_b16 a[172:173], v22 offset:27648
    ds_read_b64_tr_b16 a[174:175], v22 offset:27904
    s_waitcnt lgkmcnt(8)
    v_mfma_f32_32x32x16_bf16 v[32:47], a[144:147], a[96:99], v[32:47]
    v_cvt_pk_bf16_f32 v216, v112, v113
    s_add_u32 m0, s40, 61440
    s_add_u32 s62, s41, 221184
    buffer_load_dwordx4 v9, s[16:19], s62 offen  lds
    ds_read_b64_tr_b16 a[144:145], v22 offset:10240
    ds_read_b64_tr_b16 a[146:147], v22 offset:10496
    v_mfma_f32_32x32x16_bf16 v[64:79], a[148:151], a[96:99], v[64:79]
    v_max_f32 v114, 0, v114
    ds_read_b64_tr_b16 a[148:149], v22 offset:28672
    ds_read_b64_tr_b16 a[150:151], v22 offset:28928
    v_mfma_f32_32x32x16_bf16 v[32:47], a[152:155], a[100:103], v[32:47]
    v_max_f32 v115, 0, v115
    s_add_u32 m0, s40, 65536
    s_add_u32 s62, s41, 258048
    buffer_load_dwordx4 v9, s[16:19], s62 offen  lds
    ds_read_b64_tr_b16 a[152:153], v22 offset:11264
    ds_read_b64_tr_b16 a[154:155], v22 offset:11520
    v_mfma_f32_32x32x16_bf16 v[64:79], a[156:159], a[100:103], v[64:79]
    v_mul_f32 v114, v114, v146
    ds_read_b64_tr_b16 a[156:157], v22 offset:29696
    ds_read_b64_tr_b16 a[158:159], v22 offset:29952
    s_waitcnt lgkmcnt(8)
    v_mfma_f32_32x32x16_bf16 v[32:47], a[160:163], a[104:107], v[32:47]
    v_mul_f32 v115, v115, v147
    s_add_u32 m0, s40, 69632
    s_add_u32 s62, s45, 0
    buffer_load_dwordx4 v9, s[16:19], s62 offen  lds
    ds_read_b64_tr_b16 a[160:161], v22 offset:12288
    ds_read_b64_tr_b16 a[162:163], v22 offset:12544
    v_mfma_f32_32x32x16_bf16 v[64:79], a[164:167], a[104:107], v[64:79]
    v_cvt_pk_bf16_f32 v217, v114, v115
    ds_read_b64_tr_b16 a[164:165], v22 offset:30720
    ds_read_b64_tr_b16 a[166:167], v22 offset:30976
    v_mfma_f32_32x32x16_bf16 v[32:47], a[168:171], a[108:111], v[32:47]
    v_max_f32 v116, 0, v116
    s_add_u32 s64, s53, 4096
    buffer_load_dwordx4 a[240:243], v0, s[20:23], s64 offen sc1
    ds_read_b64_tr_b16 a[168:169], v22 offset:13312
    ds_read_b64_tr_b16 a[170:171], v22 offset:13568
    v_mfma_f32_32x32x16_bf16 v[64:79], a[172:175], a[108:111], v[64:79]
    v_max_f32 v117, 0, v117
    s_add_u32 s64, s53, 5120
    buffer_load_dwordx4 a[244:247], v0, s[20:23], s64 offen sc1
    ds_read_b64_tr_b16 a[172:173], v22 offset:31744
    ds_read_b64_tr_b16 a[174:175], v22 offset:32000
    s_waitcnt lgkmcnt(8)
    v_mfma_f32_32x32x16_bf16 v[32:47], a[144:147], a[112:115], v[32:47]
    v_mul_f32 v116, v116, v148
    ds_read_b64_tr_b16 a[144:145], v22 offset:14336
    ds_read_b64_tr_b16 a[146:147], v22 offset:14592
    v_mfma_f32_32x32x16_bf16 v[64:79], a[148:151], a[112:115], v[64:79]
    v_mul_f32 v117, v117, v149
    s_add_u32 s64, s53, 6144
    buffer_load_dwordx4 a[0:3], v0, s[20:23], s64 offen sc1
    ds_read_b64_tr_b16 a[148:149], v22 offset:32768
    ds_read_b64_tr_b16 a[150:151], v22 offset:33024
    v_mfma_f32_32x32x16_bf16 v[32:47], a[152:155], a[116:119], v[32:47]
    v_cvt_pk_bf16_f32 v218, v116, v117
    ds_read_b64_tr_b16 a[152:153], v22 offset:15360
    ds_read_b64_tr_b16 a[154:155], v22 offset:15616
    v_mfma_f32_32x32x16_bf16 v[64:79], a[156:159], a[116:119], v[64:79]
    v_max_f32 v118, 0, v118
    s_add_u32 s64, s53, 7168
    buffer_load_dwordx4 a[4:7], v0, s[20:23], s64 offen sc1
    ds_read_b64_tr_b16 a[156:157], v22 offset:33792
    ds_read_b64_tr_b16 a[158:159], v22 offset:34048
    s_waitcnt lgkmcnt(8)
    v_mfma_f32_32x32x16_bf16 v[32:47], a[160:163], a[120:123], v[32:47]
    v_max_f32 v119, 0, v119
    s_add_u32 s64, s54, 4096
    buffer_load_dwordx4 a[8:11], v0, s[20:23], s64 offen sc1
    ds_read_b64_tr_b16 a[160:161], v22 offset:16384
    ds_read_b64_tr_b16 a[162:163], v22 offset:16640
    v_mfma_f32_32x32x16_bf16 v[64:79], a[164:167], a[120:123], v[64:79]
    v_mul_f32 v118, v118, v150
    ds_read_b64_tr_b16 a[164:165], v22 offset:34816
    ds_read_b64_tr_b16 a[166:167], v22 offset:35072
    v_mfma_f32_32x32x16_bf16 v[32:47], a[168:171], a[124:127], v[32:47]
    v_mul_f32 v119, v119, v151
    s_add_u32 s64, s54, 5120
    buffer_load_dwordx4 a[12:15], v0, s[20:23], s64 offen sc1
    ds_read_b64_tr_b16 a[168:169], v22 offset:17408
    ds_read_b64_tr_b16 a[170:171], v22 offset:17664
    v_mfma_f32_32x32x16_bf16 v[64:79], a[172:175], a[124:127], v[64:79]
    v_cvt_pk_bf16_f32 v219, v118, v119
    ds_read_b64_tr_b16 a[172:173], v22 offset:35840
    ds_read_b64_tr_b16 a[174:175], v22 offset:36096
    s_waitcnt lgkmcnt(8)
    v_mfma_f32_32x32x16_bf16 v[32:47], a[144:147], a[128:131], v[32:47]
    s_waitcnt vmcnt(30)
    s_barrier
    s_add_u32 s63, s51, 14336
    buffer_store_dwordx4 v[216:219], v0, s[20:23], s63 offen sc1
    v_max_f32 v120, 0, v120
    s_add_u32 s64, s54, 6144
    buffer_load_dwordx4 a[16:19], v0, s[20:23], s64 offen sc1
    ds_read_b64_tr_b16 a[144:145], v29 offset:0
    ds_read_b64_tr_b16 a[146:147], v29 offset:1024
    v_mfma_f32_32x32x16_bf16 v[64:79], a[148:151], a[128:131], v[64:79]
    v_max_f32 v121, 0, v121
    s_add_u32 s64, s54, 7168
    buffer_load_dwordx4 a[20:23], v0, s[20:23], s64 offen sc1
    ds_read_b64_tr_b16 a[148:149], v30 offset:0
    ds_read_b64_tr_b16 a[150:151], v30 offset:1024
    v_mfma_f32_32x32x16_bf16 v[32:47], a[152:155], a[132:135], v[32:47]
    v_mul_f32 v120, v120, v152
    ds_read_b64_tr_b16 a[152:153], v29 offset:2048
    ds_read_b64_tr_b16 a[154:155], v29 offset:3072
    v_mfma_f32_32x32x16_bf16 v[64:79], a[156:159], a[132:135], v[64:79]
    v_mul_f32 v121, v121, v153
    ds_read_b64_tr_b16 a[156:157], v30 offset:2048
    ds_read_b64_tr_b16 a[158:159], v30 offset:3072
    s_waitcnt lgkmcnt(8)
    v_mfma_f32_32x32x16_bf16 v[32:47], a[160:163], a[136:139], v[32:47]
    v_cvt_pk_bf16_f32 v220, v120, v121
    ds_read_b64_tr_b16 a[160:161], v29 offset:4096
    ds_read_b64_tr_b16 a[162:163], v29 offset:5120
    v_mfma_f32_32x32x16_bf16 v[64:79], a[164:167], a[136:139], v[64:79]
    v_max_f32 v122, 0, v122
    ds_read_b64_tr_b16 a[164:165], v30 offset:4096
    ds_read_b64_tr_b16 a[166:167], v30 offset:5120
    v_mfma_f32_32x32x16_bf16 v[32:47], a[168:171], a[140:143], v[32:47]
    v_max_f32 v123, 0, v123
    ds_read_b64_tr_b16 a[168:169], v29 offset:6144
    ds_read_b64_tr_b16 a[170:171], v29 offset:7168
    v_mfma_f32_32x32x16_bf16 v[64:79], a[172:175], a[140:143], v[64:79]
    s_barrier
    v_mul_f32 v122, v122, v154
    ds_read_b64_tr_b16 a[172:173], v30 offset:6144
    ds_read_b64_tr_b16 a[174:175], v30 offset:7168
    s_waitcnt lgkmcnt(8)
    v_mfma_f32_32x32x16_bf16 v[48:63], a[144:147], v[160:163], 0
    s_cbranch_vccnz W0_10
    buffer_load_dwordx4 v[248:251], off, s[20:23], s73 sc1
W0_10:
    v_mul_f32 v123, v123, v155
    s_add_u32 m0, s40, 73728
    s_add_u32 s62, s42, 0
    s_add_u32 s62, s62, s3
    buffer_load_dwordx4 v9, s[16:19], s62 offen  lds
    ds_read_b64_tr_b16 a[144:145], v29 offset:8192
    ds_read_b64_tr_b16 a[146:147], v29 offset:9216
    v_mfma_f32_32x32x16_bf16 v[80:95], a[148:151], v[160:163], 0
    v_cvt_pk_bf16_f32 v221, v122, v123
    ds_read_b64_tr_b16 a[148:149], v30 offset:8192
    ds_read_b64_tr_b16 a[150:151], v30 offset:9216
    v_mfma_f32_32x32x16_bf16 v[48:63], a[152:155], v[164:167], v[48:63]
    v_max_f32 v124, 0, v124
    s_add_u32 m0, s40, 77824
    s_add_u32 s62, s42, 36864
    s_add_u32 s62, s62, s3
    buffer_load_dwordx4 v9, s[16:19], s62 offen  lds
    ds_read_b64_tr_b16 a[152:153], v29 offset:10240
    ds_read_b64_tr_b16 a[154:155], v29 offset:11264
    v_mfma_f32_32x32x16_bf16 v[80:95], a[156:159], v[164:167], v[80:95]
    v_max_f32 v125, 0, v125
    ds_read_b64_tr_b16 a[156:157], v30 offset:10240
    ds_read_b64_tr_b16 a[158:159], v30 offset:11264
    s_waitcnt lgkmcnt(8)
    v_mfma_f32_32x32x16_bf16 v[48:63], a[160:163], v[168:171], v[48:63]
    v_mul_f32 v124, v124, v156
    v_max_f32 v32, 0, v32
    v_max_f32 v33, 0, v33
    s_add_u32 m0, s40, 81920
    s_add_u32 s62, s43, 0
    s_add_u32 s62, s62, s3
    buffer_load_dwordx4 v9, s[16:19], s62 offen  lds
    ds_read_b64_tr_b16 a[160:161], v29 offset:12288
    ds_read_b64_tr_b16 a[162:163], v29 offset:13312
    v_mfma_f32_32x32x16_bf16 v[80:95], a[164:167], v[168:171], v[80:95]
    v_mul_f32 v125, v125, v157
    v_mul_f32 v32, v32, v64
    v_mul_f32 v33, v33, v65
    ds_read_b64_tr_b16 a[164:165], v30 offset:12288
    ds_read_b64_tr_b16 a[166:167], v30 offset:13312
    v_mfma_f32_32x32x16_bf16 v[48:63], a[168:171], v[172:175], v[48:63]
    v_cvt_pk_bf16_f32 v222, v124, v125
    v_cvt_pk_bf16_f32 v224, v32, v33
    v_max_f32 v34, 0, v34
    s_add_u32 m0, s40, 86016
    s_add_u32 s62, s43, 36864
    s_add_u32 s62, s62, s3
    buffer_load_dwordx4 v9, s[16:19], s62 offen  lds
    ds_read_b64_tr_b16 a[168:169], v29 offset:14336
    ds_read_b64_tr_b16 a[170:171], v29 offset:15360
    v_mfma_f32_32x32x16_bf16 v[80:95], a[172:175], v[172:175], v[80:95]
    v_max_f32 v126, 0, v126
    v_max_f32 v35, 0, v35
    v_mul_f32 v34, v34, v66
    ds_read_b64_tr_b16 a[172:173], v30 offset:14336
    ds_read_b64_tr_b16 a[174:175], v30 offset:15360
    s_waitcnt lgkmcnt(8)
    v_mfma_f32_32x32x16_bf16 v[48:63], a[144:147], v[176:179], v[48:63]
    v_max_f32 v127, 0, v127
    v_mul_f32 v35, v35, v67
    v_cvt_pk_bf16_f32 v225, v34, v35
    s_add_u32 m0, s40, 90112
    s_add_u32 s62, s44, 0
    s_add_u32 s62, s62, s3
    buffer_load_dwordx4 v9, s[16:19], s62 offen  lds
    ds_read_b64_tr_b16 a[144:145], v29 offset:16384
    ds_read_b64_tr_b16 a[146:147], v29 offset:17408
    v_mfma_f32_32x32x16_bf16 v[80:95], a[148:151], v[176:179], v[80:95]
    v_mul_f32 v126, v126, v158
    v_max_f32 v36, 0, v36
    v_max_f32 v37, 0, v37
    ds_read_b64_tr_b16 a[148:149], v30 offset:16384
    ds_read_b64_tr_b16 a[150:151], v30 offset:17408
    v_mfma_f32_32x32x16_bf16 v[48:63], a[152:155], v[180:183], v[48:63]
    v_mul_f32 v127, v127, v159
    v_mul_f32 v36, v36, v68
    v_mul_f32 v37, v37, v69
    s_add_u32 m0, s40, 94208
    s_add_u32 s62, s44, 36864
    s_add_u32 s62, s62, s3
    buffer_load_dwordx4 v9, s[16:19], s62 offen  lds
    ds_read_b64_tr_b16 a[152:153], v29 offset:18432
    ds_read_b64_tr_b16 a[154:155], v29 offset:19456
    v_mfma_f32_32x32x16_bf16 v[80:95], a[156:159], v[180:183], v[80:95]
    v_cvt_pk_bf16_f32 v223, v126, v127
    v_cvt_pk_bf16_f32 v226, v36, v37
    v_max_f32 v38, 0, v38
    ds_read_b64_tr_b16 a[156:157], v30 offset:18432
    ds_read_b64_tr_b16 a[158:159], v30 offset:19456
    s_waitcnt lgkmcnt(8)
    v_mfma_f32_32x32x16_bf16 v[48:63], a[160:163], v[184:187], v[48:63]
    s_add_u32 s63, s51, 15360
    buffer_store_dwordx4 v[220:223], v0, s[20:23], s63 offen sc1
    v_max_f32 v39, 0, v39
    v_mul_f32 v38, v38, v70
    s_add_u32 m0, s40, 98304
    s_add_u32 s62, s42, 73728
    s_add_u32 s62, s62, s3
    buffer_load_dwordx4 v9, s[16:19], s62 offen  lds
    ds_read_b64_tr_b16 a[160:161], v29 offset:20480
    ds_read_b64_tr_b16 a[162:163], v29 offset:21504
    v_mfma_f32_32x32x16_bf16 v[80:95], a[164:167], v[184:187], v[80:95]
    v_mul_f32 v39, v39, v71
    v_cvt_pk_bf16_f32 v227, v38, v39
    ds_read_b64_tr_b16 a[164:165], v30 offset:20480
    ds_read_b64_tr_b16 a[166:167], v30 offset:21504
    v_mfma_f32_32x32x16_bf16 v[48:63], a[168:171], v[188:191], v[48:63]
    s_add_u32 s63, s51, 16384
    buffer_store_dwordx4 v[224:227], v0, s[20:23], s63 offen sc1
    v_max_f32 v40, 0, v40
    v_max_f32 v41, 0, v41
    s_add_u32 m0, s40, 102400
    s_add_u32 s62, s42, 110592
    s_add_u32 s62, s62, s3
    buffer_load_dwordx4 v9, s[16:19], s62 offen  lds
    ds_read_b64_tr_b16 a[168:169], v29 offset:22528
    ds_read_b64_tr_b16 a[170:171], v29 offset:23552
    v_mfma_f32_32x32x16_bf16 v[80:95], a[172:175], v[188:191], v[80:95]
    v_mul_f32 v40, v40, v72
    v_mul_f32 v41, v41, v73
    ds_read_b64_tr_b16 a[172:173], v30 offset:22528
    ds_read_b64_tr_b16 a[174:175], v30 offset:23552
    s_waitcnt lgkmcnt(8)
    v_mfma_f32_32x32x16_bf16 v[48:63], a[144:147], v[192:195], v[48:63]
    v_cvt_pk_bf16_f32 v228, v40, v41
    v_max_f32 v42, 0, v42
    s_add_u32 m0, s40, 106496
    s_add_u32 s62, s43, 73728
    s_add_u32 s62, s62, s3
    buffer_load_dwordx4 v9, s[16:19], s62 offen  lds
    ds_read_b64_tr_b16 a[144:145], v29 offset:24576
    ds_read_b64_tr_b16 a[146:147], v29 offset:25600
    v_mfma_f32_32x32x16_bf16 v[80:95], a[148:151], v[192:195], v[80:95]
    v_max_f32 v43, 0, v43
    v_mul_f32 v42, v42, v74
    ds_read_b64_tr_b16 a[148:149], v30 offset:24576
    ds_read_b64_tr_b16 a[150:151], v30 offset:25600
    v_mfma_f32_32x32x16_bf16 v[48:63], a[152:155], v[196:199], v[48:63]
    v_mul_f32 v43, v43, v75
    v_cvt_pk_bf16_f32 v229, v42, v43
    ds_read_b64_tr_b16 a[152:153], v29 offset:26624
    ds_read_b64_tr_b16 a[154:155], v29 offset:27648
    v_mfma_f32_32x32x16_bf16 v[80:95], a[156:159], v[196:199], v[80:95]
    v_max_f32 v44, 0, v44
    v_max_f32 v45, 0, v45
    ds_read_b64_tr_b16 a[156:157], v30 offset:26624
    ds_read_b64_tr_b16 a[158:159], v30 offset:27648
    s_waitcnt lgkmcnt(8)
    v_mfma_f32_32x32x16_bf16 v[48:63], a[160:163], v[200:203], v[48:63]
    v_mul_f32 v44, v44, v76
    v_mul_f32 v45, v45, v77
    ds_read_b64_tr_b16 a[160:161], v29 offset:28672
    ds_read_b64_tr_b16 a[162:163], v29 offset:29696
    v_mfma_f32_32x32x16_bf16 v[80:95], a[164:167], v[200:203], v[80:95]
    v_cvt_pk_bf16_f32 v230, v44, v45
    v_max_f32 v46, 0, v46
    ds_read_b64_tr_b16 a[164:165], v30 offset:28672
    ds_read_b64_tr_b16 a[166:167], v30 offset:29696
    v_mfma_f32_32x32x16_bf16 v[48:63], a[168:171], v[204:207], v[48:63]
    v_max_f32 v47, 0, v47
    v_mul_f32 v46, v46, v78
    ds_read_b64_tr_b16 a[168:169], v29 offset:30720
    ds_read_b64_tr_b16 a[170:171], v29 offset:31744
    v_mfma_f32_32x32x16_bf16 v[80:95], a[172:175], v[204:207], v[80:95]
    v_mul_f32 v47, v47, v79
    v_cvt_pk_bf16_f32 v231, v46, v47
    ds_read_b64_tr_b16 a[172:173], v30 offset:30720
    ds_read_b64_tr_b16 a[174:175], v30 offset:31744
    s_waitcnt lgkmcnt(8)
    v_mfma_f32_32x32x16_bf16 v[48:63], a[144:147], v[208:211], v[48:63]
    s_add_u32 s63, s51, 17408
    buffer_store_dwordx4 v[228:231], v0, s[20:23], s63 offen sc1
    ds_read_b64_tr_b16 a[144:145], v29 offset:32768
    ds_read_b64_tr_b16 a[146:147], v29 offset:33792
    v_mfma_f32_32x32x16_bf16 v[80:95], a[148:151], v[208:211], v[80:95]
    ds_read_b64_tr_b16 a[148:149], v30 offset:32768
    ds_read_b64_tr_b16 a[150:151], v30 offset:33792
    v_mfma_f32_32x32x16_bf16 v[48:63], a[152:155], v[212:215], v[48:63]
    ds_read_b64_tr_b16 a[152:153], v29 offset:34816
    ds_read_b64_tr_b16 a[154:155], v29 offset:35840
    v_mfma_f32_32x32x16_bf16 v[80:95], a[156:159], v[212:215], v[80:95]
    ds_read_b64_tr_b16 a[156:157], v30 offset:34816
    ds_read_b64_tr_b16 a[158:159], v30 offset:35840
    s_waitcnt lgkmcnt(8)
    v_mfma_f32_32x32x16_bf16 v[48:63], a[160:163], v[216:219], v[48:63]
    s_waitcnt vmcnt(34)
    s_cbranch_vccnz W0_11
    s_waitcnt vmcnt(12)
    s_add_u32 s78, s72, 3
    v_subrev_u32 v248, s78, v248
    v_subrev_u32 v249, s78, v249
    v_subrev_u32 v250, s78, v250
    v_subrev_u32 v251, s78, v251
    v_or_b32 v248, v248, v249
    v_or_b32 v250, v250, v251
    v_or_b32 v248, v248, v250
    v_cmp_gt_u32 s[82:83], 8, v248
    s_nop 1
    s_cmp_eq_u64 s[82:83], -1
    s_cbranch_scc0 SLOW3
OK3:
W0_11:
    s_barrier
    ds_read_b64_tr_b16 a[160:161], v23 offset:0
    ds_read_b64_tr_b16 a[162:163], v23 offset:1024
    v_mfma_f32_32x32x16_bf16 v[80:95], a[164:167], v[216:219], v[80:95]
    s_add_u32 s64, s52, 8192
    buffer_load_dwordx4 a[24:27], v0, s[20:23], s64 offen sc1
    ds_read_b64_tr_b16 a[164:165], v24 offset:0
    ds_read_b64_tr_b16 a[166:167], v24 offset:1024
    v_mfma_f32_32x32x16_bf16 v[48:63], a[168:171], v[220:223], v[48:63]
    ds_read_b64_tr_b16 a[168:169], v23 offset:2048
    ds_read_b64_tr_b16 a[170:171], v23 offset:3072
    v_mfma_f32_32x32x16_bf16 v[80:95], a[172:175], v[220:223], v[80:95]
    s_add_u32 s64, s52, 9216
    buffer_load_dwordx4 a[28:31], v0, s[20:23], s64 offen sc1
    ds_read_b64_tr_b16 a[172:173], v24 offset:2048
    ds_read_b64_tr_b16 a[174:175], v24 offset:3072
    s_waitcnt lgkmcnt(8)
    v_mfma_f32_32x32x16_bf16 v[48:63], a[144:147], v[224:227], v[48:63]
    ds_read_b64_tr_b16 a[144:145], v23 offset:4096
    ds_read_b64_tr_b16 a[146:147], v23 offset:5120
    v_mfma_f32_32x32x16_bf16 v[80:95], a[148:151], v[224:227], v[80:95]
    s_add_u32 s64, s52, 10240
    buffer_load_dwordx4 a[32:35], v0, s[20:23], s64 offen sc1
    ds_read_b64_tr_b16 a[148:149], v24 offset:4096
    ds_read_b64_tr_b16 a[150:151], v24 offset:5120
    v_mfma_f32_32x32x16_bf16 v[48:63], a[152:155], v[228:231], v[48:63]
    ds_read_b64_tr_b16 a[152:153], v23 offset:6144
    ds_read_b64_tr_b16 a[154:155], v23 offset:7168
    v_mfma_f32_32x32x16_bf16 v[80:95], a[156:159], v[228:231], v[80:95]
    s_barrier
    ds_read_b64_tr_b16 a[156:157], v24 offset:6144
    ds_read_b64_tr_b16 a[158:159], v24 offset:7168
    s_waitcnt lgkmcnt(8)
    v_mfma_f32_32x32x16_bf16 v[96:111], a[160:163], v[160:163], 0
    s_add_u32 m0, s40, 110592
    s_add_u32 s62, s43, 110592
    s_add_u32 s62, s62, s3
    buffer_load_dwordx4 v9, s[16:19], s62 offen  lds
    ds_read_b64_tr_b16 a[160:161], v23 offset:8192
    ds_read_b64_tr_b16 a[162:163], v23 offset:9216
    v_mfma_f32_32x32x16_bf16 v[112:127], a[164:167], v[160:163], 0
    ds_read_b64_tr_b16 a[164:165], v24 offset:8192
    ds_read_b64_tr_b16 a[166:167], v24 offset:9216
    v_mfma_f32_32x32x16_bf16 v[96:111], a[168:171], v[164:167], v[96:111]
    s_add_u32 m0, s40, 114688
    s_add_u32 s62, s44, 73728
    s_add_u32 s62, s62, s3
    buffer_load_dwordx4 v9, s[16:19], s62 offen  lds
    ds_read_b64_tr_b16 a[168:169], v23 offset:10240
    ds_read_b64_tr_b16 a[170:171], v23 offset:11264
    v_mfma_f32_32x32x16_bf16 v[112:127], a[172:175], v[164:167], v[112:127]
    ds_read_b64_tr_b16 a[172:173], v24 offset:10240
    ds_read_b64_tr_b16 a[174:175], v24 offset:11264
    s_waitcnt lgkmcnt(8)
    v_mfma_f32_32x32x16_bf16 v[96:111], a[144:147], v[168:171], v[96:111]
    s_add_u32 m0, s40, 118784
    s_add_u32 s62, s44, 110592
    s_add_u32 s62, s62, s3
    buffer_load_dwordx4 v9, s[16:19], s62 offen  lds
    ds_read_b64_tr_b16 a[144:145], v23 offset:12288
    ds_read_b64_tr_b16 a[146:147], v23 offset:13312
    v_mfma_f32_32x32x16_bf16 v[112:127], a[148:151], v[168:171], v[112:127]
    ds_read_b64_tr_b16 a[148:149], v24 offset:12288
    ds_read_b64_tr_b16 a[150:151], v24 offset:13312
    v_mfma_f32_32x32x16_bf16 v[96:111], a[152:155], v[172:175], v[96:111]
    s_add_u32 m0, s40, 122880
    s_add_u32 s62, s42, 147456
    s_add_u32 s62, s62, s3
    buffer_load_dwordx4 v9, s[16:19], s62 offen  lds
    ds_read_b64_tr_b16 a[152:153], v23 offset:14336
    ds_read_b64_tr_b16 a[154:155], v23 offset:15360
    v_mfma_f32_32x32x16_bf16 v[112:127], a[156:159], v[172:175], v[112:127]
    ds_read_b64_tr_b16 a[156:157], v24 offset:14336
    ds_read_b64_tr_b16 a[158:159], v24 offset:15360
    s_waitcnt lgkmcnt(8)
    v_mfma_f32_32x32x16_bf16 v[96:111], a[160:163], v[176:179], v[96:111]
    s_add_u32 m0, s40, 126976
    s_add_u32 s62, s42, 184320
    s_add_u32 s62, s62, s3
    buffer_load_dwordx4 v9, s[16:19], s62 offen  lds
    ds_read_b64_tr_b16 a[160:161], v23 offset:16384
    ds_read_b64_tr_b16 a[162:163], v23 offset:17408
    v_mfma_f32_32x32x16_bf16 v[112:127], a[164:167], v[176:179], v[112:127]
    ds_read_b64_tr_b16 a[164:165], v24 offset:16384
    ds_read_b64_tr_b16 a[166:167], v24 offset:17408
    v_mfma_f32_32x32x16_bf16 v[96:111], a[168:171], v[180:183], v[96:111]
    s_add_u32 m0, s40, 131072
    s_add_u32 s62, s43, 147456
    s_add_u32 s62, s62, s3
    buffer_load_dwordx4 v9, s[16:19], s62 offen  lds
    ds_read_b64_tr_b16 a[168:169], v23 offset:18432
    ds_read_b64_tr_b16 a[170:171], v23 offset:19456
    v_mfma_f32_32x32x16_bf16 v[112:127], a[172:175], v[180:183], v[112:127]
    ds_read_b64_tr_b16 a[172:173], v24 offset:18432
    ds_read_b64_tr_b16 a[174:175], v24 offset:19456
    s_waitcnt lgkmcnt(8)
    v_mfma_f32_32x32x16_bf16 v[96:111], a[144:147], v[184:187], v[96:111]
    s_add_u32 m0, s40, 135168
    s_add_u32 s62, s43, 184320
    s_add_u32 s62, s62, s3
    buffer_load_dwordx4 v9, s[16:19], s62 offen  lds
    ds_read_b64_tr_b16 a[144:145], v23 offset:20480
    ds_read_b64_tr_b16 a[146:147], v23 offset:21504
    v_mfma_f32_32x32x16_bf16 v[112:127], a[148:151], v[184:187], v[112:127]
    ds_read_b64_tr_b16 a[148:149], v24 offset:20480
    ds_read_b64_tr_b16 a[150:151], v24 offset:21504
    v_mfma_f32_32x32x16_bf16 v[96:111], a[152:155], v[188:191], v[96:111]
    s_add_u32 m0, s40, 139264
    s_add_u32 s62, s44, 147456
    s_add_u32 s62, s62, s3
    buffer_load_dwordx4 v9, s[16:19], s62 offen  lds
    ds_read_b64_tr_b16 a[152:153], v23 offset:22528
    ds_read_b64_tr_b16 a[154:155], v23 offset:23552
    v_mfma_f32_32x32x16_bf16 v[112:127], a[156:159], v[188:191], v[112:127]
    ds_read_b64_tr_b16 a[156:157], v24 offset:22528
    ds_read_b64_tr_b16 a[158:159], v24 offset:23552
    s_waitcnt lgkmcnt(8)
    v_mfma_f32_32x32x16_bf16 v[96:111], a[160:163], v[192:195], v[96:111]
    s_add_u32 m0, s40, 143360
    s_add_u32 s62, s44, 184320
    s_add_u32 s62, s62, s3
    buffer_load_dwordx4 v9, s[16:19], s62 offen  lds
    ds_read_b64_tr_b16 a[160:161], v23 offset:24576
    ds_read_b64_tr_b16 a[162:163], v23 offset:25600
    v_mfma_f32_32x32x16_bf16 v[112:127], a[164:167], v[192:195], v[112:127]
    ds_read_b64_tr_b16 a[164:165], v24 offset:24576
    ds_read_b64_tr_b16 a[166:167], v24 offset:25600
    v_mfma_f32_32x32x16_bf16 v[96:111], a[168:171], v[196:199], v[96:111]
    v_cvt_pk_bf16_f32 v232, v48, v49
    v_cvt_pk_bf16_f32 v233, v50, v51
    s_add_u32 s64, s52, 11264
    buffer_load_dwordx4 a[36:39], v0, s[20:23], s64 offen sc1
    ds_read_b64_tr_b16 a[168:169], v23 offset:26624
    ds_read_b64_tr_b16 a[170:171], v23 offset:27648
    v_mfma_f32_32x32x16_bf16 v[112:127], a[172:175], v[196:199], v[112:127]
    v_cvt_pk_bf16_f32 v234, v52, v53
    v_cvt_pk_bf16_f32 v235, v54, v55
    s_add_u32 s64, s53, 8192
    buffer_load_dwordx4 a[40:43], v0, s[20:23], s64 offen sc1
    ds_read_b64_tr_b16 a[172:173], v24 offset:26624
    ds_read_b64_tr_b16 a[174:175], v24 offset:27648
    s_waitcnt lgkmcnt(8)
    v_mfma_f32_32x32x16_bf16 v[96:111], a[144:147], v[200:203], v[96:111]
    s_add_u32 s63, s57, 0
    buffer_store_dwordx4 v[232:235], v0, s[20:23], s63 offen sc1
    ds_read_b64_tr_b16 a[144:145], v23 offset:28672
    ds_read_b64_tr_b16 a[146:147], v23 offset:29696
    v_mfma_f32_32x32x16_bf16 v[112:127], a[148:151], v[200:203], v[112:127]
    v_cvt_pk_bf16_f32 v236, v56, v57
    v_cvt_pk_bf16_f32 v237, v58, v59
    s_add_u32 s64, s53, 9216
    buffer_load_dwordx4 a[44:47], v0, s[20:23], s64 offen sc1
    ds_read_b64_tr_b16 a[148:149], v24 offset:28672
    ds_read_b64_tr_b16 a[150:151], v24 offset:29696
    v_mfma_f32_32x32x16_bf16 v[96:111], a[152:155], v[204:207], v[96:111]
    v_cvt_pk_bf16_f32 v238, v60, v61
    v_cvt_pk_bf16_f32 v239, v62, v63
    ds_read_b64_tr_b16 a[152:153], v23 offset:30720
    ds_read_b64_tr_b16 a[154:155], v23 offset:31744
    v_mfma_f32_32x32x16_bf16 v[112:127], a[156:159], v[204:207], v[112:127]
    s_add_u32 s63, s57, 16384
    buffer_store_dwordx4 v[236:239], v0, s[20:23], s63 offen sc1
    s_add_u32 s64, s53, 10240
    buffer_load_dwordx4 a[48:51], v0, s[20:23], s64 offen sc1
    ds_read_b64_tr_b16 a[156:157], v24 offset:30720
    ds_read_b64_tr_b16 a[158:159], v24 offset:31744
    s_waitcnt lgkmcnt(8)
    v_mfma_f32_32x32x16_bf16 v[96:111], a[160:163], v[208:211], v[96:111]
    v_cvt_pk_bf16_f32 v240, v80, v81
    v_cvt_pk_bf16_f32 v241, v82, v83
    s_add_u32 s64, s53, 11264
    buffer_load_dwordx4 a[52:55], v0, s[20:23], s64 offen sc1
    ds_read_b64_tr_b16 a[160:161], v23 offset:32768
    ds_read_b64_tr_b16 a[162:163], v23 offset:33792
    v_mfma_f32_32x32x16_bf16 v[112:127], a[164:167], v[208:211], v[112:127]
    v_cvt_pk_bf16_f32 v242, v84, v85
    v_cvt_pk_bf16_f32 v243, v86, v87
    ds_read_b64_tr_b16 a[164:165], v24 offset:32768
    ds_read_b64_tr_b16 a[166:167], v24 offset:33792
    v_mfma_f32_32x32x16_bf16 v[96:111], a[168:171], v[212:215], v[96:111]
    s_add_u32 s63, s0, 0
    buffer_store_dwordx4 v[240:243], v0, s[20:23], s63 offen sc1
    s_add_u32 s64, s54, 8192
    buffer_load_dwordx4 a[56:59], v0, s[20:23], s64 offen sc1
    ds_read_b64_tr_b16 a[168:169], v23 offset:34816
    ds_read_b64_tr_b16 a[170:171], v23 offset:35840
    v_mfma_f32_32x32x16_bf16 v[112:127], a[172:175], v[212:215], v[112:127]
    v_cvt_pk_bf16_f32 v244, v88, v89
    v_cvt_pk_bf16_f32 v245, v90, v91
    ds_read_b64_tr_b16 a[172:173], v24 offset:34816
    ds_read_b64_tr_b16 a[174:175], v24 offset:35840
    s_waitcnt lgkmcnt(8)
    v_mfma_f32_32x32x16_bf16 v[96:111], a[144:147], v[216:219], v[96:111]
    s_waitcnt vmcnt(42)
    s_waitcnt vmcnt(21)
    s_barrier
    s_cbranch_vccnz W0_12
    s_add_u32 s78, s72, 4
    v_mov_b32 v252, s78
    buffer_store_dword v252, off, s[20:23], s76 sc1
W0_12:
    v_cvt_pk_bf16_f32 v246, v92, v93
    v_cvt_pk_bf16_f32 v247, v94, v95
    s_add_u32 s64, s54, 9216
    buffer_load_dwordx4 a[60:63], v0, s[20:23], s64 offen sc1
    ds_read_b64_tr_b16 a[144:145], v25 offset:0
    ds_read_b64_tr_b16 a[146:147], v25 offset:1024
    v_mfma_f32_32x32x16_bf16 v[112:127], a[148:151], v[216:219], v[112:127]
    s_add_u32 s63, s0, 16384
    buffer_store_dwordx4 v[244:247], v0, s[20:23], s63 offen sc1
    s_add_u32 s64, s54, 10240
    buffer_load_dwordx4 a[64:67], v0, s[20:23], s64 offen sc1
    ds_read_b64_tr_b16 a[148:149], v26 offset:0
    ds_read_b64_tr_b16 a[150:151], v26 offset:1024
    v_mfma_f32_32x32x16_bf16 v[96:111], a[152:155], v[220:223], v[96:111]
    ds_read_b64_tr_b16 a[152:153], v25 offset:2048
    ds_read_b64_tr_b16 a[154:155], v25 offset:3072
    v_mfma_f32_32x32x16_bf16 v[112:127], a[156:159], v[220:223], v[112:127]
    s_add_u32 s64, s54, 11264
    buffer_load_dwordx4 a[68:71], v0, s[20:23], s64 offen sc1
    ds_read_b64_tr_b16 a[156:157], v26 offset:2048
    ds_read_b64_tr_b16 a[158:159], v26 offset:3072
    s_waitcnt lgkmcnt(8)
    v_mfma_f32_32x32x16_bf16 v[96:111], a[160:163], v[224:227], v[96:111]
    ds_read_b64_tr_b16 a[160:161], v25 offset:4096
    ds_read_b64_tr_b16 a[162:163], v25 offset:5120
    v_mfma_f32_32x32x16_bf16 v[112:127], a[164:167], v[224:227], v[112:127]
    ds_read_b64_tr_b16 a[164:165], v26 offset:4096
    ds_read_b64_tr_b16 a[166:167], v26 offset:5120
    v_mfma_f32_32x32x16_bf16 v[96:111], a[168:171], v[228:231], v[96:111]
    ds_read_b64_tr_b16 a[168:169], v25 offset:6144
    ds_read_b64_tr_b16 a[170:171], v25 offset:7168
    v_mfma_f32_32x32x16_bf16 v[112:127], a[172:175], v[228:231], v[112:127]
    s_barrier
    ds_read_b64_tr_b16 a[172:173], v26 offset:6144
    ds_read_b64_tr_b16 a[174:175], v26 offset:7168
    s_waitcnt lgkmcnt(8)
    v_mfma_f32_32x32x16_bf16 v[128:143], a[144:147], v[160:163], 0
    s_add_u32 m0, s40, 0
    s_add_u32 s62, s42, 0
    buffer_load_dwordx4 v9, s[16:19], s62 offen  lds
    ds_read_b64_tr_b16 a[144:145], v25 offset:8192
    ds_read_b64_tr_b16 a[146:147], v25 offset:9216
    v_mfma_f32_32x32x16_bf16 v[144:159], a[148:151], v[160:163], 0
    ds_read_b64_tr_b16 a[148:149], v26 offset:8192
    ds_read_b64_tr_b16 a[150:151], v26 offset:9216
    v_mfma_f32_32x32x16_bf16 v[128:143], a[152:155], v[164:167], v[128:143]
    s_add_u32 m0, s40, 4096
    s_add_u32 s62, s42, 36864
    buffer_load_dwordx4 v9, s[16:19], s62 offen  lds
    ds_read_b64_tr_b16 a[152:153], v25 offset:10240
    ds_read_b64_tr_b16 a[154:155], v25 offset:11264
    v_mfma_f32_32x32x16_bf16 v[144:159], a[156:159], v[164:167], v[144:159]
    ds_read_b64_tr_b16 a[156:157], v26 offset:10240
    ds_read_b64_tr_b16 a[158:159], v26 offset:11264
    s_waitcnt lgkmcnt(8)
    v_mfma_f32_32x32x16_bf16 v[128:143], a[160:163], v[168:171], v[128:143]
    s_add_u32 m0, s40, 8192
    s_add_u32 s62, s43, 0
    buffer_load_dwordx4 v9, s[16:19], s62 offen  lds
    ds_read_b64_tr_b16 a[160:161], v25 offset:12288
    ds_read_b64_tr_b16 a[162:163], v25 offset:13312
    v_mfma_f32_32x32x16_bf16 v[144:159], a[164:167], v[168:171], v[144:159]
    ds_read_b64_tr_b16 a[164:165], v26 offset:12288
    ds_read_b64_tr_b16 a[166:167], v26 offset:13312
    v_mfma_f32_32x32x16_bf16 v[128:143], a[168:171], v[172:175], v[128:143]
    s_add_u32 m0, s40, 12288
    s_add_u32 s62, s43, 36864
    buffer_load_dwordx4 v9, s[16:19], s62 offen  lds
    ds_read_b64_tr_b16 a[168:169], v25 offset:14336
    ds_read_b64_tr_b16 a[170:171], v25 offset:15360
    v_mfma_f32_32x32x16_bf16 v[144:159], a[172:175], v[172:175], v[144:159]
    ds_read_b64_tr_b16 a[172:173], v26 offset:14336
    ds_read_b64_tr_b16 a[174:175], v26 offset:15360
    s_waitcnt lgkmcnt(8)
    v_mfma_f32_32x32x16_bf16 v[128:143], a[144:147], v[176:179], v[128:143]
    s_add_u32 m0, s40, 16384
    s_add_u32 s62, s44, 0
    buffer_load_dwordx4 v9, s[16:19], s62 offen  lds
    ds_read_b64_tr_b16 a[144:145], v25 offset:16384
    ds_read_b64_tr_b16 a[146:147], v25 offset:17408
    v_mfma_f32_32x32x16_bf16 v[144:159], a[148:151], v[176:179], v[144:159]
    ds_read_b64_tr_b16 a[148:149], v26 offset:16384
    ds_read_b64_tr_b16 a[150:151], v26 offset:17408
    v_mfma_f32_32x32x16_bf16 v[128:143], a[152:155], v[180:183], v[128:143]
    s_add_u32 m0, s40, 20480
    s_add_u32 s62, s44, 36864
    buffer_load_dwordx4 v9, s[16:19], s62 offen  lds
    ds_read_b64_tr_b16 a[152:153], v25 offset:18432
    ds_read_b64_tr_b16 a[154:155], v25 offset:19456
    v_mfma_f32_32x32x16_bf16 v[144:159], a[156:159], v[180:183], v[144:159]
    ds_read_b64_tr_b16 a[156:157], v26 offset:18432
    ds_read_b64_tr_b16 a[158:159], v26 offset:19456
    s_waitcnt lgkmcnt(8)
    v_mfma_f32_32x32x16_bf16 v[128:143], a[160:163], v[184:187], v[128:143]
    s_add_u32 m0, s40, 24576
    s_add_u32 s62, s42, 73728
    buffer_load_dwordx4 v9, s[16:19], s62 offen  lds
    ds_read_b64_tr_b16 a[160:161], v25 offset:20480
    ds_read_b64_tr_b16 a[162:163], v25 offset:21504
    v_mfma_f32_32x32x16_bf16 v[144:159], a[164:167], v[184:187], v[144:159]
    ds_read_b64_tr_b16 a[164:165], v26 offset:20480
    ds_read_b64_tr_b16 a[166:167], v26 offset:21504
    v_mfma_f32_32x32x16_bf16 v[128:143], a[168:171], v[188:191], v[128:143]
    s_add_u32 m0, s40, 28672
    s_add_u32 s62, s42, 110592
    buffer_load_dwordx4 v9, s[16:19], s62 offen  lds
    ds_read_b64_tr_b16 a[168:169], v25 offset:22528
    ds_read_b64_tr_b16 a[170:171], v25 offset:23552
    v_mfma_f32_32x32x16_bf16 v[144:159], a[172:175], v[188:191], v[144:159]
    ds_read_b64_tr_b16 a[172:173], v26 offset:22528
    ds_read_b64_tr_b16 a[174:175], v26 offset:23552
    s_waitcnt lgkmcnt(8)
    v_mfma_f32_32x32x16_bf16 v[128:143], a[144:147], v[192:195], v[128:143]
    s_add_u32 m0, s40, 32768
    s_add_u32 s62, s43, 73728
    buffer_load_dwordx4 v9, s[16:19], s62 offen  lds
    ds_read_b64_tr_b16 a[144:145], v25 offset:24576
    ds_read_b64_tr_b16 a[146:147], v25 offset:25600
    v_mfma_f32_32x32x16_bf16 v[144:159], a[148:151], v[192:195], v[144:159]
    ds_read_b64_tr_b16 a[148:149], v26 offset:24576
    ds_read_b64_tr_b16 a[150:151], v26 offset:25600
    v_mfma_f32_32x32x16_bf16 v[128:143], a[152:155], v[196:199], v[128:143]
    ds_read_b64_tr_b16 a[152:153], v25 offset:26624
    ds_read_b64_tr_b16 a[154:155], v25 offset:27648
    v_mfma_f32_32x32x16_bf16 v[144:159], a[156:159], v[196:199], v[144:159]
    ds_read_b64_tr_b16 a[156:157], v26 offset:26624
    ds_read_b64_tr_b16 a[158:159], v26 offset:27648
    s_waitcnt lgkmcnt(8)
    v_mfma_f32_32x32x16_bf16 v[128:143], a[160:163], v[200:203], v[128:143]
    ds_read_b64_tr_b16 a[160:161], v25 offset:28672
    ds_read_b64_tr_b16 a[162:163], v25 offset:29696
    v_mfma_f32_32x32x16_bf16 v[144:159], a[164:167], v[200:203], v[144:159]
    ds_read_b64_tr_b16 a[164:165], v26 offset:28672
    ds_read_b64_tr_b16 a[166:167], v26 offset:29696
    v_mfma_f32_32x32x16_bf16 v[128:143], a[168:171], v[204:207], v[128:143]
    ds_read_b64_tr_b16 a[168:169], v25 offset:30720
    ds_read_b64_tr_b16 a[170:171], v25 offset:31744
    v_mfma_f32_32x32x16_bf16 v[144:159], a[172:175], v[204:207], v[144:159]
    ds_read_b64_tr_b16 a[172:173], v26 offset:30720
    ds_read_b64_tr_b16 a[174:175], v26 offset:31744
    s_waitcnt lgkmcnt(8)
    v_mfma_f32_32x32x16_bf16 v[128:143], a[144:147], v[208:211], v[128:143]
    ds_read_b64_tr_b16 a[144:145], v25 offset:32768
    ds_read_b64_tr_b16 a[146:147], v25 offset:33792
    v_mfma_f32_32x32x16_bf16 v[144:159], a[148:151], v[208:211], v[144:159]
    ds_read_b64_tr_b16 a[148:149], v26 offset:32768
    ds_read_b64_tr_b16 a[150:151], v26 offset:33792
    v_mfma_f32_32x32x16_bf16 v[128:143], a[152:155], v[212:215], v[128:143]
    ds_read_b64_tr_b16 a[152:153], v25 offset:34816
    ds_read_b64_tr_b16 a[154:155], v25 offset:35840
    v_mfma_f32_32x32x16_bf16 v[144:159], a[156:159], v[212:215], v[144:159]
    ds_read_b64_tr_b16 a[156:157], v26 offset:34816
    ds_read_b64_tr_b16 a[158:159], v26 offset:35840
    s_waitcnt lgkmcnt(8)
    v_mfma_f32_32x32x16_bf16 v[128:143], a[160:163], v[216:219], v[128:143]
    s_barrier
    ds_read_b64_tr_b16 a[160:161], v27 offset:0
    ds_read_b64_tr_b16 a[162:163], v27 offset:1024
    v_mfma_f32_32x32x16_bf16 v[144:159], a[164:167], v[216:219], v[144:159]
    ds_read_b64_tr_b16 a[164:165], v28 offset:0
    ds_read_b64_tr_b16 a[166:167], v28 offset:1024
    v_mfma_f32_32x32x16_bf16 v[128:143], a[168:171], v[220:223], v[128:143]
    ds_read_b64_tr_b16 a[168:169], v27 offset:2048
    ds_read_b64_tr_b16 a[170:171], v27 offset:3072
    v_mfma_f32_32x32x16_bf16 v[144:159], a[172:175], v[220:223], v[144:159]
    ds_read_b64_tr_b16 a[172:173], v28 offset:2048
    ds_read_b64_tr_b16 a[174:175], v28 offset:3072
    s_waitcnt lgkmcnt(8)
    v_mfma_f32_32x32x16_bf16 v[128:143], a[144:147], v[224:227], v[128:143]
    ds_read_b64_tr_b16 a[144:145], v27 offset:4096
    ds_read_b64_tr_b16 a[146:147], v27 offset:5120
    v_mfma_f32_32x32x16_bf16 v[144:159], a[148:151], v[224:227], v[144:159]
    ds_read_b64_tr_b16 a[148:149], v28 offset:4096
    ds_read_b64_tr_b16 a[150:151], v28 offset:5120
    v_mfma_f32_32x32x16_bf16 v[128:143], a[152:155], v[228:231], v[128:143]
    ds_read_b64_tr_b16 a[152:153], v27 offset:6144
    ds_read_b64_tr_b16 a[154:155], v27 offset:7168
    v_mfma_f32_32x32x16_bf16 v[144:159], a[156:159], v[228:231], v[144:159]
    s_barrier
    ds_read_b64_tr_b16 a[156:157], v28 offset:6144
    ds_read_b64_tr_b16 a[158:159], v28 offset:7168
    s_waitcnt lgkmcnt(8)
    v_mfma_f32_32x32x16_bf16 v[96:111], a[160:163], a[176:179], v[96:111]
    s_add_u32 m0, s40, 36864
    s_add_u32 s62, s43, 110592
    buffer_load_dwordx4 v9, s[16:19], s62 offen  lds
    ds_read_b64_tr_b16 a[160:161], v27 offset:8192
    ds_read_b64_tr_b16 a[162:163], v27 offset:9216
    v_mfma_f32_32x32x16_bf16 v[112:127], a[164:167], a[176:179], v[112:127]
    ds_read_b64_tr_b16 a[164:165], v28 offset:8192
    ds_read_b64_tr_b16 a[166:167], v28 offset:9216
    v_mfma_f32_32x32x16_bf16 v[96:111], a[168:171], a[180:183], v[96:111]
    s_add_u32 m0, s40, 40960
    s_add_u32 s62, s44, 73728
    buffer_load_dwordx4 v9, s[16:19], s62 offen  lds
    ds_read_b64_tr_b16 a[168:169], v27 offset:10240
    ds_read_b64_tr_b16 a[170:171], v27 offset:11264
    v_mfma_f32_32x32x16_bf16 v[112:127], a[172:175], a[180:183], v[112:127]
    ds_read_b64_tr_b16 a[172:173], v28 offset:10240
    ds_read_b64_tr_b16 a[174:175], v28 offset:11264
    s_waitcnt lgkmcnt(8)
    v_mfma_f32_32x32x16_bf16 v[96:111], a[144:147], a[184:187], v[96:111]
    s_add_u32 m0, s40, 45056
    s_add_u32 s62, s44, 110592
    buffer_load_dwordx4 v9, s[16:19], s62 offen  lds
    ds_read_b64_tr_b16 a[144:145], v27 offset:12288
    ds_read_b64_tr_b16 a[146:147], v27 offset:13312
    v_mfma_f32_32x32x16_bf16 v[112:127], a[148:151], a[184:187], v[112:127]
    ds_read_b64_tr_b16 a[148:149], v28 offset:12288
    ds_read_b64_tr_b16 a[150:151], v28 offset:13312
    v_mfma_f32_32x32x16_bf16 v[96:111], a[152:155], a[188:191], v[96:111]
    s_add_u32 m0, s40, 49152
    s_add_u32 s62, s42, 147456
    buffer_load_dwordx4 v9, s[16:19], s62 offen  lds
    ds_read_b64_tr_b16 a[152:153], v27 offset:14336
    ds_read_b64_tr_b16 a[154:155], v27 offset:15360
    v_mfma_f32_32x32x16_bf16 v[112:127], a[156:159], a[188:191], v[112:127]
    ds_read_b64_tr_b16 a[156:157], v28 offset:14336
    ds_read_b64_tr_b16 a[158:159], v28 offset:15360
    s_waitcnt lgkmcnt(8)
    v_mfma_f32_32x32x16_bf16 v[96:111], a[160:163], a[192:195], v[96:111]
    s_add_u32 m0, s40, 53248
    s_add_u32 s62, s42, 184320
    buffer_load_dwordx4 v9, s[16:19], s62 offen  lds
    ds_read_b64_tr_b16 a[160:161], v27 offset:16384
    ds_read_b64_tr_b16 a[162:163], v27 offset:17408
    v_mfma_f32_32x32x16_bf16 v[112:127], a[164:167], a[192:195], v[112:127]
    ds_read_b64_tr_b16 a[164:165], v28 offset:16384
    ds_read_b64_tr_b16 a[166:167], v28 offset:17408
    v_mfma_f32_32x32x16_bf16 v[96:111], a[168:171], a[196:199], v[96:111]
    s_add_u32 m0, s40, 57344
    s_add_u32 s62, s43, 147456
    buffer_load_dwordx4 v9, s[16:19], s62 offen  lds
    ds_read_b64_tr_b16 a[168:169], v27 offset:18432
    ds_read_b64_tr_b16 a[170:171], v27 offset:19456
    v_mfma_f32_32x32x16_bf16 v[112:127], a[172:175], a[196:199], v[112:127]
    s_cbranch_vccnz W0_13
    buffer_load_dwordx4 v[248:251], off, s[20:23], s73 sc1
W0_13:
    ds_read_b64_tr_b16 a[172:173], v28 offset:18432
    ds_read_b64_tr_b16 a[174:175], v28 offset:19456
    s_waitcnt lgkmcnt(8)
    v_mfma_f32_32x32x16_bf16 v[96:111], a[144:147], a[200:203], v[96:111]
    s_add_u32 m0, s40, 61440
    s_add_u32 s62, s43, 184320
    buffer_load_dwordx4 v9, s[16:19], s62 offen  lds
    ds_read_b64_tr_b16 a[144:145], v27 offset:20480
    ds_read_b64_tr_b16 a[146:147], v27 offset:21504
    v_mfma_f32_32x32x16_bf16 v[112:127], a[148:151], a[200:203], v[112:127]
    ds_read_b64_tr_b16 a[148:149], v28 offset:20480
    ds_read_b64_tr_b16 a[150:151], v28 offset:21504
    v_mfma_f32_32x32x16_bf16 v[96:111], a[152:155], a[204:207], v[96:111]
    s_add_u32 m0, s40, 65536
    s_add_u32 s62, s44, 147456
    buffer_load_dwordx4 v9, s[16:19], s62 offen  lds
    ds_read_b64_tr_b16 a[152:153], v27 offset:22528
    ds_read_b64_tr_b16 a[154:155], v27 offset:23552
    v_mfma_f32_32x32x16_bf16 v[112:127], a[156:159], a[204:207], v[112:127]
    ds_read_b64_tr_b16 a[156:157], v28 offset:22528
    ds_read_b64_tr_b16 a[158:159], v28 offset:23552
    s_waitcnt lgkmcnt(8)
    v_mfma_f32_32x32x16_bf16 v[96:111], a[160:163], a[208:211], v[96:111]
    s_add_u32 m0, s40, 69632
    s_add_u32 s62, s44, 184320
    buffer_load_dwordx4 v9, s[16:19], s62 offen  lds
    ds_read_b64_tr_b16 a[160:161], v27 offset:24576
    ds_read_b64_tr_b16 a[162:163], v27 offset:25600
    v_mfma_f32_32x32x16_bf16 v[112:127], a[164:167], a[208:211], v[112:127]
    ds_read_b64_tr_b16 a[164:165], v28 offset:24576
    ds_read_b64_tr_b16 a[166:167], v28 offset:25600
    v_mfma_f32_32x32x16_bf16 v[96:111], a[168:171], a[212:215], v[96:111]
    ds_read_b64_tr_b16 a[168:169], v27 offset:26624
    ds_read_b64_tr_b16 a[170:171], v27 offset:27648
    v_mfma_f32_32x32x16_bf16 v[112:127], a[172:175], a[212:215], v[112:127]
    ds_read_b64_tr_b16 a[172:173], v28 offset:26624
    ds_read_b64_tr_b16 a[174:175], v28 offset:27648
    s_waitcnt lgkmcnt(8)
    v_mfma_f32_32x32x16_bf16 v[96:111], a[144:147], a[216:219], v[96:111]
    ds_read_b64_tr_b16 a[144:145], v27 offset:28672
    ds_read_b64_tr_b16 a[146:147], v27 offset:29696
    v_mfma_f32_32x32x16_bf16 v[112:127], a[148:151], a[216:219], v[112:127]
    ds_read_b64_tr_b16 a[148:149], v28 offset:28672
    ds_read_b64_tr_b16 a[150:151], v28 offset:29696
    v_mfma_f32_32x32x16_bf16 v[96:111], a[152:155], a[220:223], v[96:111]
    ds_read_b64_tr_b16 a[152:153], v27 offset:30720
    ds_read_b64_tr_b16 a[154:155], v27 offset:31744
    v_mfma_f32_32x32x16_bf16 v[112:127], a[156:159], a[220:223], v[112:127]
    ds_read_b64_tr_b16 a[156:157], v28 offset:30720
    ds_read_b64_tr_b16 a[158:159], v28 offset:31744
    s_waitcnt lgkmcnt(8)
    v_mfma_f32_32x32x16_bf16 v[96:111], a[160:163], a[224:227], v[96:111]
    ds_read_b64_tr_b16 a[160:161], v27 offset:32768
    ds_read_b64_tr_b16 a[162:163], v27 offset:33792
    v_mfma_f32_32x32x16_bf16 v[112:127], a[164:167], a[224:227], v[112:127]
    ds_read_b64_tr_b16 a[164:165], v28 offset:32768
    ds_read_b64_tr_b16 a[166:167], v28 offset:33792
    v_mfma_f32_32x32x16_bf16 v[96:111], a[168:171], a[228:231], v[96:111]
    ds_read_b64_tr_b16 a[168:169], v27 offset:34816
    ds_read_b64_tr_b16 a[170:171], v27 offset:35840
    v_mfma_f32_32x32x16_bf16 v[112:127], a[172:175], a[228:231], v[112:127]
    ds_read_b64_tr_b16 a[172:173], v28 offset:34816
    ds_read_b64_tr_b16 a[174:175], v28 offset:35840
    s_waitcnt lgkmcnt(8)
    v_mfma_f32_32x32x16_bf16 v[96:111], a[144:147], a[232:235], v[96:111]
    s_waitcnt vmcnt(31)
    s_waitcnt vmcnt(20)
    s_barrier
    s_cbranch_vccnz W0_14
    s_add_u32 s78, s72, 5
    v_mov_b32 v252, s78
    buffer_store_dword v252, off, s[20:23], s76 sc1
W0_14:
    ds_read_b64_tr_b16 a[144:145], v29 offset:0
    ds_read_b64_tr_b16 a[146:147], v29 offset:1024
    v_mfma_f32_32x32x16_bf16 v[112:127], a[148:151], a[232:235], v[112:127]
    ds_read_b64_tr_b16 a[148:149], v30 offset:0
    ds_read_b64_tr_b16 a[150:151], v30 offset:1024
    v_mfma_f32_32x32x16_bf16 v[96:111], a[152:155], a[236:239], v[96:111]
    ds_read_b64_tr_b16 a[152:153], v29 offset:2048
    ds_read_b64_tr_b16 a[154:155], v29 offset:3072
    v_mfma_f32_32x32x16_bf16 v[112:127], a[156:159], a[236:239], v[112:127]
    ds_read_b64_tr_b16 a[156:157], v30 offset:2048
    ds_read_b64_tr_b16 a[158:159], v30 offset:3072
    s_waitcnt lgkmcnt(8)
    v_mfma_f32_32x32x16_bf16 v[96:111], a[160:163], a[240:243], v[96:111]
    ds_read_b64_tr_b16 a[160:161], v29 offset:4096
    ds_read_b64_tr_b16 a[162:163], v29 offset:5120
    v_mfma_f32_32x32x16_bf16 v[112:127], a[164:167], a[240:243], v[112:127]
    ds_read_b64_tr_b16 a[164:165], v30 offset:4096
    ds_read_b64_tr_b16 a[166:167], v30 offset:5120
    v_mfma_f32_32x32x16_bf16 v[96:111], a[168:171], a[244:247], v[96:111]
    ds_read_b64_tr_b16 a[168:169], v29 offset:6144
    ds_read_b64_tr_b16 a[170:171], v29 offset:7168
    v_mfma_f32_32x32x16_bf16 v[112:127], a[172:175], a[244:247], v[112:127]
    s_cbranch_vccnz W0_15
    s_waitcnt vmcnt(4)
    s_add_u32 s78, s72, 4
    v_subrev_u32 v248, s78, v248
    v_subrev_u32 v249, s78, v249
    v_subrev_u32 v250, s78, v250
    v_subrev_u32 v251, s78, v251
    v_or_b32 v248, v248, v249
    v_or_b32 v250, v250, v251
    v_or_b32 v248, v248, v250
    v_cmp_gt_u32 s[82:83], 8, v248
    s_nop 1
    s_cmp_eq_u64 s[82:83], -1
    s_cbranch_scc0 SLOW4
OK4:
W0_15:
    s_barrier
    ds_read_b64_tr_b16 a[172:173], v30 offset:6144
    ds_read_b64_tr_b16 a[174:175], v30 offset:7168
    s_waitcnt lgkmcnt(8)
    v_mfma_f32_32x32x16_bf16 v[96:111], a[144:147], a[0:3], v[96:111]
    s_add_u32 m0, s40, 73728
    s_add_u32 s62, s42, 221184
    s_add_u32 s62, s62, s3
    buffer_load_dwordx4 v9, s[16:19], s62 offen  lds
    ds_read_b64_tr_b16 a[144:145], v29 offset:8192
    ds_read_b64_tr_b16 a[146:147], v29 offset:9216
    v_mfma_f32_32x32x16_bf16 v[112:127], a[148:151], a[0:3], v[112:127]
    ds_read_b64_tr_b16 a[148:149], v30 offset:8192
    ds_read_b64_tr_b16 a[150:151], v30 offset:9216
    v_mfma_f32_32x32x16_bf16 v[96:111], a[152:155], a[4:7], v[96:111]
    s_add_u32 m0, s40, 77824
    s_add_u32 s62, s42, 258048
    s_add_u32 s62, s62, s3
    buffer_load_dwordx4 v9, s[16:19], s62 offen  lds
    ds_read_b64_tr_b16 a[152:153], v29 offset:10240
    ds_read_b64_tr_b16 a[154:155], v29 offset:11264
    v_mfma_f32_32x32x16_bf16 v[112:127], a[156:159], a[4:7], v[112:127]
    ds_read_b64_tr_b16 a[156:157], v30 offset:10240
    ds_read_b64_tr_b16 a[158:159], v30 offset:11264
    s_waitcnt lgkmcnt(8)
    v_mfma_f32_32x32x16_bf16 v[96:111], a[160:163], a[8:11], v[96:111]
    s_add_u32 m0, s40, 81920
    s_add_u32 s62, s46, 0
    s_add_u32 s62, s62, s3
    buffer_load_dwordx4 v9, s[16:19], s62 offen  lds
    ds_read_b64_tr_b16 a[160:161], v29 offset:12288
    ds_read_b64_tr_b16 a[162:163], v29 offset:13312
    v_mfma_f32_32x32x16_bf16 v[112:127], a[164:167], a[8:11], v[112:127]
    ds_read_b64_tr_b16 a[164:165], v30 offset:12288
    ds_read_b64_tr_b16 a[166:167], v30 offset:13312
    v_mfma_f32_32x32x16_bf16 v[96:111], a[168:171], a[12:15], v[96:111]
    s_add_u32 m0, s40, 86016
    s_add_u32 s62, s43, 221184
    s_add_u32 s62, s62, s3
    buffer_load_dwordx4 v9, s[16:19], s62 offen  lds
    ds_read_b64_tr_b16 a[168:169], v29 offset:14336
    ds_read_b64_tr_b16 a[170:171], v29 offset:15360
    v_mfma_f32_32x32x16_bf16 v[112:127], a[172:175], a[12:15], v[112:127]
    ds_read_b64_tr_b16 a[172:173], v30 offset:14336
    ds_read_b64_tr_b16 a[174:175], v30 offset:15360
    s_waitcnt lgkmcnt(8)
    v_mfma_f32_32x32x16_bf16 v[96:111], a[144:147], a[16:19], v[96:111]
    s_add_u32 m0, s40, 90112
    s_add_u32 s62, s43, 258048
    s_add_u32 s62, s62, s3
    buffer_load_dwordx4 v9, s[16:19], s62 offen  lds
    ds_read_b64_tr_b16 a[144:145], v29 offset:16384
    ds_read_b64_tr_b16 a[146:147], v29 offset:17408
    v_mfma_f32_32x32x16_bf16 v[112:127], a[148:151], a[16:19], v[112:127]
    ds_read_b64_tr_b16 a[148:149], v30 offset:16384
    ds_read_b64_tr_b16 a[150:151], v30 offset:17408
    v_mfma_f32_32x32x16_bf16 v[96:111], a[152:155], a[20:23], v[96:111]
    s_add_u32 m0, s40, 94208
    s_add_u32 s62, s47, 0
    s_add_u32 s62, s62, s3
    buffer_load_dwordx4 v9, s[16:19], s62 offen  lds
    ds_read_b64_tr_b16 a[152:153], v29 offset:18432
    ds_read_b64_tr_b16 a[154:155], v29 offset:19456
    v_mfma_f32_32x32x16_bf16 v[112:127], a[156:159], a[20:23], v[112:127]
    ds_read_b64_tr_b16 a[156:157], v30 offset:18432
    ds_read_b64_tr_b16 a[158:159], v30 offset:19456
    s_waitcnt lgkmcnt(8)
    v_mfma_f32_32x32x16_bf16 v[96:111], a[160:163], a[24:27], v[96:111]
    s_add_u32 m0, s40, 98304
    s_add_u32 s62, s44, 221184
    s_add_u32 s62, s62, s3
    buffer_load_dwordx4 v9, s[16:19], s62 offen  lds
    ds_read_b64_tr_b16 a[160:161], v29 offset:20480
    ds_read_b64_tr_b16 a[162:163], v29 offset:21504
    v_mfma_f32_32x32x16_bf16 v[112:127], a[164:167], a[24:27], v[112:127]
    ds_read_b64_tr_b16 a[164:165], v30 offset:20480
    ds_read_b64_tr_b16 a[166:167], v30 offset:21504
    v_mfma_f32_32x32x16_bf16 v[96:111], a[168:171], a[28:31], v[96:111]
    s_add_u32 m0, s40, 102400
    s_add_u32 s62, s44, 258048
    s_add_u32 s62, s62, s3
    buffer_load_dwordx4 v9, s[16:19], s62 offen  lds
    ds_read_b64_tr_b16 a[168:169], v29 offset:22528
    ds_read_b64_tr_b16 a[170:171], v29 offset:23552
    v_mfma_f32_32x32x16_bf16 v[112:127], a[172:175], a[28:31], v[112:127]
    ds_read_b64_tr_b16 a[172:173], v30 offset:22528
    ds_read_b64_tr_b16 a[174:175], v30 offset:23552
    s_waitcnt lgkmcnt(8)
    v_mfma_f32_32x32x16_bf16 v[96:111], a[144:147], a[32:35], v[96:111]
    s_add_u32 m0, s40, 106496
    s_add_u32 s62, s48, 0
    s_add_u32 s62, s62, s3
    buffer_load_dwordx4 v9, s[16:19], s62 offen  lds
    ds_read_b64_tr_b16 a[144:145], v29 offset:24576
    ds_read_b64_tr_b16 a[146:147], v29 offset:25600
    v_mfma_f32_32x32x16_bf16 v[112:127], a[148:151], a[32:35], v[112:127]
    ds_read_b64_tr_b16 a[148:149], v30 offset:24576
    ds_read_b64_tr_b16 a[150:151], v30 offset:25600
    v_mfma_f32_32x32x16_bf16 v[96:111], a[152:155], a[36:39], v[96:111]
    s_add_u32 s64, s52, 12288
    buffer_load_dwordx4 a[72:75], v0, s[20:23], s64 offen sc1
    ds_read_b64_tr_b16 a[152:153], v29 offset:26624
    ds_read_b64_tr_b16 a[154:155], v29 offset:27648
    v_mfma_f32_32x32x16_bf16 v[112:127], a[156:159], a[36:39], v[112:127]
    s_add_u32 s64, s52, 13312
    buffer_load_dwordx4 a[76:79], v0, s[20:23], s64 offen sc1
    ds_read_b64_tr_b16 a[156:157], v30 offset:26624
    ds_read_b64_tr_b16 a[158:159], v30 offset:27648
    s_waitcnt lgkmcnt(8)
    v_mfma_f32_32x32x16_bf16 v[96:111], a[160:163], a[40:43], v[96:111]
    ds_read_b64_tr_b16 a[160:161], v29 offset:28672
    ds_read_b64_tr_b16 a[162:163], v29 offset:29696
    v_mfma_f32_32x32x16_bf16 v[112:127], a[164:167], a[40:43], v[112:127]
    s_add_u32 s64, s52, 14336
    buffer_load_dwordx4 a[80:83], v0, s[20:23], s64 offen sc1
    ds_read_b64_tr_b16 a[164:165], v30 offset:28672
    ds_read_b64_tr_b16 a[166:167], v30 offset:29696
    v_mfma_f32_32x32x16_bf16 v[96:111], a[168:171], a[44:47], v[96:111]
    ds_read_b64_tr_b16 a[168:169], v29 offset:30720
    ds_read_b64_tr_b16 a[170:171], v29 offset:31744
    v_mfma_f32_32x32x16_bf16 v[112:127], a[172:175], a[44:47], v[112:127]
    s_add_u32 s64, s52, 15360
    buffer_load_dwordx4 a[84:87], v0, s[20:23], s64 offen sc1
    ds_read_b64_tr_b16 a[172:173], v30 offset:30720
    ds_read_b64_tr_b16 a[174:175], v30 offset:31744
    s_waitcnt lgkmcnt(8)
    v_mfma_f32_32x32x16_bf16 v[96:111], a[144:147], a[48:51], v[96:111]
    s_add_u32 s64, s52, 16384
    buffer_load_dwordx4 a[88:91], v0, s[20:23], s64 offen sc1
    ds_read_b64_tr_b16 a[144:145], v29 offset:32768
    ds_read_b64_tr_b16 a[146:147], v29 offset:33792
    v_mfma_f32_32x32x16_bf16 v[112:127], a[148:151], a[48:51], v[112:127]
    ds_read_b64_tr_b16 a[148:149], v30 offset:32768
    ds_read_b64_tr_b16 a[150:151], v30 offset:33792
    v_mfma_f32_32x32x16_bf16 v[96:111], a[152:155], a[52:55], v[96:111]
    s_add_u32 s64, s52, 17408
    buffer_load_dwordx4 a[92:95], v0, s[20:23], s64 offen sc1
    ds_read_b64_tr_b16 a[152:153], v29 offset:34816
    ds_read_b64_tr_b16 a[154:155], v29 offset:35840
    v_mfma_f32_32x32x16_bf16 v[112:127], a[156:159], a[52:55], v[112:127]
    ds_read_b64_tr_b16 a[156:157], v30 offset:34816
    ds_read_b64_tr_b16 a[158:159], v30 offset:35840
    s_waitcnt lgkmcnt(8)
    v_mfma_f32_32x32x16_bf16 v[96:111], a[160:163], a[56:59], v[96:111]
    s_waitcnt vmcnt(24)
    s_barrier
    s_add_u32 s64, s53, 12288
    buffer_load_dwordx4 a[96:99], v0, s[20:23], s64 offen sc1
    ds_read_b64_tr_b16 a[160:161], v23 offset:0
    ds_read_b64_tr_b16 a[162:163], v23 offset:1024
    v_mfma_f32_32x32x16_bf16 v[112:127], a[164:167], a[56:59], v[112:127]
    s_add_u32 s64, s53, 13312
    buffer_load_dwordx4 a[100:103], v0, s[20:23], s64 offen sc1
    ds_read_b64_tr_b16 a[164:165], v23 offset:2048
    ds_read_b64_tr_b16 a[166:167], v23 offset:3072
    v_mfma_f32_32x32x16_bf16 v[96:111], a[168:171], a[60:63], v[96:111]
    ds_read_b64_tr_b16 a[168:169], v23 offset:4096
    ds_read_b64_tr_b16 a[170:171], v23 offset:5120
    v_mfma_f32_32x32x16_bf16 v[112:127], a[172:175], a[60:63], v[112:127]
    s_add_u32 s64, s53, 14336
    buffer_load_dwordx4 a[104:107], v0, s[20:23], s64 offen sc1
    ds_read_b64_tr_b16 a[172:173], v23 offset:6144
    ds_read_b64_tr_b16 a[174:175], v23 offset:7168
    s_waitcnt lgkmcnt(8)
    v_mfma_f32_32x32x16_bf16 v[96:111], a[144:147], a[64:67], v[96:111]
    ds_read_b64_tr_b16 a[144:145], v23 offset:8192
    ds_read_b64_tr_b16 a[146:147], v23 offset:9216
    v_mfma_f32_32x32x16_bf16 v[112:127], a[148:151], a[64:67], v[112:127]
    s_add_u32 s64, s53, 15360
    buffer_load_dwordx4 a[108:111], v0, s[20:23], s64 offen sc1
    ds_read_b64_tr_b16 a[148:149], v23 offset:10240
    ds_read_b64_tr_b16 a[150:151], v23 offset:11264
    v_mfma_f32_32x32x16_bf16 v[96:111], a[152:155], a[68:71], v[96:111]
    ds_read_b64_tr_b16 a[152:153], v23 offset:12288
    ds_read_b64_tr_b16 a[154:155], v23 offset:13312
    v_mfma_f32_32x32x16_bf16 v[112:127], a[156:159], a[68:71], v[112:127]
    s_barrier
    ds_read_b64_tr_b16 a[156:157], v23 offset:14336
    ds_read_b64_tr_b16 a[158:159], v23 offset:15360
    s_waitcnt lgkmcnt(8)
    v_mfma_f32_32x32x16_bf16 v[128:143], a[160:163], a[176:179], v[128:143]
    s_add_u32 m0, s40, 110592
    s_add_u32 s62, s42, 221184
    buffer_load_dwordx4 v9, s[16:19], s62 offen  lds
    ds_read_b64_tr_b16 a[160:161], v23 offset:16384
    ds_read_b64_tr_b16 a[162:163], v23 offset:17408
    v_mfma_f32_32x32x16_bf16 v[128:143], a[164:167], a[180:183], v[128:143]
    ds_read_b64_tr_b16 a[164:165], v23 offset:18432
    ds_read_b64_tr_b16 a[166:167], v23 offset:19456
    v_mfma_f32_32x32x16_bf16 v[128:143], a[168:171], a[184:187], v[128:143]
    s_add_u32 m0, s40, 114688
    s_add_u32 s62, s42, 258048
    buffer_load_dwordx4 v9, s[16:19], s62 offen  lds
    ds_read_b64_tr_b16 a[168:169], v23 offset:20480
    ds_read_b64_tr_b16 a[170:171], v23 offset:21504
    v_mfma_f32_32x32x16_bf16 v[128:143], a[172:175], a[188:191], v[128:143]
    ds_read_b64_tr_b16 a[172:173], v23 offset:22528
    ds_read_b64_tr_b16 a[174:175], v23 offset:23552
    s_waitcnt lgkmcnt(8)
    v_mfma_f32_32x32x16_bf16 v[128:143], a[144:147], a[192:195], v[128:143]
    s_add_u32 m0, s40, 118784
    s_add_u32 s62, s46, 0
    buffer_load_dwordx4 v9, s[16:19], s62 offen  lds
    ds_read_b64_tr_b16 a[144:145], v23 offset:24576
    ds_read_b64_tr_b16 a[146:147], v23 offset:25600
    v_mfma_f32_32x32x16_bf16 v[128:143], a[148:151], a[196:199], v[128:143]
    ds_read_b64_tr_b16 a[148:149], v23 offset:26624
    ds_read_b64_tr_b16 a[150:151], v23 offset:27648
    v_mfma_f32_32x32x16_bf16 v[128:143], a[152:155], a[200:203], v[128:143]
    s_add_u32 m0, s40, 122880
    s_add_u32 s62, s43, 221184
    buffer_load_dwordx4 v9, s[16:19], s62 offen  lds
    ds_read_b64_tr_b16 a[152:153], v23 offset:28672
    ds_read_b64_tr_b16 a[154:155], v23 offset:29696
    v_mfma_f32_32x32x16_bf16 v[128:143], a[156:159], a[204:207], v[128:143]
    ds_read_b64_tr_b16 a[156:157], v23 offset:30720
    ds_read_b64_tr_b16 a[158:159], v23 offset:31744
    s_waitcnt lgkmcnt(8)
    v_mfma_f32_32x32x16_bf16 v[128:143], a[160:163], a[208:211], v[128:143]
    s_add_u32 m0, s40, 126976
    s_add_u32 s62, s43, 258048
    buffer_load_dwordx4 v9, s[16:19], s62 offen  lds
    ds_read_b64_tr_b16 a[160:161], v23 offset:32768
    ds_read_b64_tr_b16 a[162:163], v23 offset:33792
    v_mfma_f32_32x32x16_bf16 v[128:143], a[164:167], a[212:215], v[128:143]
    ds_read_b64_tr_b16 a[164:165], v23 offset:34816
    ds_read_b64_tr_b16 a[166:167], v23 offset:35840
    v_mfma_f32_32x32x16_bf16 v[128:143], a[168:171], a[216:219], v[128:143]
    s_waitcnt vmcnt(24)
    s_barrier
    s_add_u32 m0, s40, 131072
    s_add_u32 s62, s47, 0
    buffer_load_dwordx4 v9, s[16:19], s62 offen  lds
    ds_read_b64_tr_b16 a[168:169], v25 offset:0
    ds_read_b64_tr_b16 a[170:171], v25 offset:1024
    v_mfma_f32_32x32x16_bf16 v[128:143], a[172:175], a[220:223], v[128:143]
    ds_read_b64_tr_b16 a[172:173], v25 offset:2048
    ds_read_b64_tr_b16 a[174:175], v25 offset:3072
    s_waitcnt lgkmcnt(8)
    v_mfma_f32_32x32x16_bf16 v[128:143], a[144:147], a[224:227], v[128:143]
    s_add_u32 m0, s40, 135168
    s_add_u32 s62, s44, 221184
    buffer_load_dwordx4 v9, s[16:19], s62 offen  lds
    ds_read_b64_tr_b16 a[144:145], v25 offset:4096
    ds_read_b64_tr_b16 a[146:147], v25 offset:5120
    v_mfma_f32_32x32x16_bf16 v[128:143], a[148:151], a[228:231], v[128:143]
    ds_read_b64_tr_b16 a[148:149], v25 offset:6144
    ds_read_b64_tr_b16 a[150:151], v25 offset:7168
    v_mfma_f32_32x32x16_bf16 v[128:143], a[152:155], a[232:235], v[128:143]
    s_add_u32 m0, s40, 139264
    s_add_u32 s62, s44, 258048
    buffer_load_dwordx4 v9, s[16:19], s62 offen  lds
    ds_read_b64_tr_b16 a[152:153], v25 offset:8192
    ds_read_b64_tr_b16 a[154:155], v25 offset:9216
    v_mfma_f32_32x32x16_bf16 v[128:143], a[156:159], a[236:239], v[128:143]
    ds_read_b64_tr_b16 a[156:157], v25 offset:10240
    ds_read_b64_tr_b16 a[158:159], v25 offset:11264
    s_waitcnt lgkmcnt(8)
    v_mfma_f32_32x32x16_bf16 v[128:143], a[160:163], a[240:243], v[128:143]
    s_add_u32 m0, s40, 143360
    s_add_u32 s62, s48, 0
    buffer_load_dwordx4 v9, s[16:19], s62 offen  lds
    ds_read_b64_tr_b16 a[160:161], v25 offset:12288
    ds_read_b64_tr_b16 a[162:163], v25 offset:13312
    v_mfma_f32_32x32x16_bf16 v[128:143], a[164:167], a[244:247], v[128:143]
    ds_read_b64_tr_b16 a[164:165], v25 offset:14336
    ds_read_b64_tr_b16 a[166:167], v25 offset:15360
    v_mfma_f32_32x32x16_bf16 v[128:143], a[168:171], a[0:3], v[128:143]
    s_add_u32 s64, s53, 16384
    buffer_load_dwordx4 a[112:115], v0, s[20:23], s64 offen sc1
    ds_read_b64_tr_b16 a[168:169], v25 offset:16384
    ds_read_b64_tr_b16 a[170:171], v25 offset:17408
    v_mfma_f32_32x32x16_bf16 v[128:143], a[172:175], a[4:7], v[128:143]
    s_add_u32 s64, s53, 17408
    buffer_load_dwordx4 a[116:119], v0, s[20:23], s64 offen sc1
    ds_read_b64_tr_b16 a[172:173], v25 offset:18432
    ds_read_b64_tr_b16 a[174:175], v25 offset:19456
    s_waitcnt lgkmcnt(8)
    v_mfma_f32_32x32x16_bf16 v[128:143], a[144:147], a[8:11], v[128:143]
    ds_read_b64_tr_b16 a[144:145], v25 offset:20480
    ds_read_b64_tr_b16 a[146:147], v25 offset:21504
    v_mfma_f32_32x32x16_bf16 v[128:143], a[148:151], a[12:15], v[128:143]
    s_add_u32 s64, s54, 12288
    buffer_load_dwordx4 a[120:123], v0, s[20:23], s64 offen sc1
    ds_read_b64_tr_b16 a[148:149], v25 offset:22528
    ds_read_b64_tr_b16 a[150:151], v25 offset:23552
    v_mfma_f32_32x32x16_bf16 v[128:143], a[152:155], a[16:19], v[128:143]
    ds_read_b64_tr_b16 a[152:153], v25 offset:24576
    ds_read_b64_tr_b16 a[154:155], v25 offset:25600
    v_mfma_f32_32x32x16_bf16 v[128:143], a[156:159], a[20:23], v[128:143]
    s_add_u32 s64, s54, 13312
    buffer_load_dwordx4 a[124:127], v0, s[20:23], s64 offen sc1
    ds_read_b64_tr_b16 a[156:157], v25 offset:26624
    ds_read_b64_tr_b16 a[158:159], v25 offset:27648
    s_waitcnt lgkmcnt(8)
    v_mfma_f32_32x32x16_bf16 v[128:143], a[160:163], a[24:27], v[128:143]
    s_add_u32 s64, s54, 14336
    buffer_load_dwordx4 a[128:131], v0, s[20:23], s64 offen sc1
    ds_read_b64_tr_b16 a[160:161], v25 offset:28672
    ds_read_b64_tr_b16 a[162:163], v25 offset:29696
    v_mfma_f32_32x32x16_bf16 v[128:143], a[164:167], a[28:31], v[128:143]
    ds_read_b64_tr_b16 a[164:165], v25 offset:30720
    ds_read_b64_tr_b16 a[166:167], v25 offset:31744
    v_mfma_f32_32x32x16_bf16 v[128:143], a[168:171], a[32:35], v[128:143]
    s_add_u32 s64, s54, 15360
    buffer_load_dwordx4 a[132:135], v0, s[20:23], s64 offen sc1
    ds_read_b64_tr_b16 a[168:169], v25 offset:32768
    ds_read_b64_tr_b16 a[170:171], v25 offset:33792
    v_mfma_f32_32x32x16_bf16 v[128:143], a[172:175], a[36:39], v[128:143]
    ds_read_b64_tr_b16 a[172:173], v25 offset:34816
    ds_read_b64_tr_b16 a[174:175], v25 offset:35840
    s_waitcnt lgkmcnt(8)
    v_mfma_f32_32x32x16_bf16 v[128:143], a[144:147], a[40:43], v[128:143]
    s_waitcnt vmcnt(25)
    s_barrier
    s_add_u32 s64, s54, 16384
    buffer_load_dwordx4 a[136:139], v0, s[20:23], s64 offen sc1
    ds_read_b64_tr_b16 a[144:145], v27 offset:0
    ds_read_b64_tr_b16 a[146:147], v27 offset:1024
    v_mfma_f32_32x32x16_bf16 v[128:143], a[148:151], a[44:47], v[128:143]
    s_add_u32 s64, s54, 17408
    buffer_load_dwordx4 a[140:143], v0, s[20:23], s64 offen sc1
    ds_read_b64_tr_b16 a[148:149], v28 offset:0
    ds_read_b64_tr_b16 a[150:151], v28 offset:1024
    v_mfma_f32_32x32x16_bf16 v[128:143], a[152:155], a[48:51], v[128:143]
    ds_read_b64_tr_b16 a[152:153], v27 offset:2048
    ds_read_b64_tr_b16 a[154:155], v27 offset:3072
    v_mfma_f32_32x32x16_bf16 v[128:143], a[156:159], a[52:55], v[128:143]
    ds_read_b64_tr_b16 a[156:157], v28 offset:2048
    ds_read_b64_tr_b16 a[158:159], v28 offset:3072
    s_waitcnt lgkmcnt(8)
    v_mfma_f32_32x32x16_bf16 v[128:143], a[160:163], a[56:59], v[128:143]
    ds_read_b64_tr_b16 a[160:161], v27 offset:4096
    ds_read_b64_tr_b16 a[162:163], v27 offset:5120
    v_mfma_f32_32x32x16_bf16 v[128:143], a[164:167], a[60:63], v[128:143]
    ds_read_b64_tr_b16 a[164:165], v28 offset:4096
    ds_read_b64_tr_b16 a[166:167], v28 offset:5120
    v_mfma_f32_32x32x16_bf16 v[128:143], a[168:171], a[64:67], v[128:143]
    ds_read_b64_tr_b16 a[168:169], v27 offset:6144
    ds_read_b64_tr_b16 a[170:171], v27 offset:7168
    v_mfma_f32_32x32x16_bf16 v[128:143], a[172:175], a[68:71], v[128:143]
    ds_read_b64_tr_b16 a[172:173], v28 offset:6144
    ds_read_b64_tr_b16 a[174:175], v28 offset:7168
    s_waitcnt vmcnt(26)
    s_waitcnt vmcnt(25)
    s_waitcnt lgkmcnt(8)
    v_mfma_f32_32x32x16_bf16 v[96:111], a[144:147], a[72:75], v[96:111]
    s_cbranch_vccnz W0_16
    buffer_load_dwordx4 v[248:251], v254, s[20:23], s74 offen sc1
W0_16:
    ds_read_b64_tr_b16 a[144:145], v27 offset:8192
    ds_read_b64_tr_b16 a[146:147], v27 offset:9216
    v_mfma_f32_32x32x16_bf16 v[112:127], a[148:151], a[72:75], v[112:127]
    ds_read_b64_tr_b16 a[148:149], v28 offset:8192
    ds_read_b64_tr_b16 a[150:151], v28 offset:9216
    v_mfma_f32_32x32x16_bf16 v[96:111], a[152:155], a[76:79], v[96:111]
    ds_read_b64_tr_b16 a[152:153], v27 offset:10240
    ds_read_b64_tr_b16 a[154:155], v27 offset:11264
    v_mfma_f32_32x32x16_bf16 v[112:127], a[156:159], a[76:79], v[112:127]
    ds_read_b64_tr_b16 a[156:157], v28 offset:10240
    ds_read_b64_tr_b16 a[158:159], v28 offset:11264
    s_waitcnt vmcnt(24)
    s_waitcnt vmcnt(23)
    s_waitcnt lgkmcnt(8)
    v_mfma_f32_32x32x16_bf16 v[96:111], a[160:163], a[80:83], v[96:111]
    ds_read_b64_tr_b16 a[160:161], v27 offset:12288
    ds_read_b64_tr_b16 a[162:163], v27 offset:13312
    v_mfma_f32_32x32x16_bf16 v[112:127], a[164:167], a[80:83], v[112:127]
    ds_read_b64_tr_b16 a[164:165], v28 offset:12288
    ds_read_b64_tr_b16 a[166:167], v28 offset:13312
    v_mfma_f32_32x32x16_bf16 v[96:111], a[168:171], a[84:87], v[96:111]
    ds_read_b64_tr_b16 a[168:169], v27 offset:14336
    ds_read_b64_tr_b16 a[170:171], v27 offset:15360
    v_mfma_f32_32x32x16_bf16 v[112:127], a[172:175], a[84:87], v[112:127]
    ds_read_b64_tr_b16 a[172:173], v28 offset:14336
    ds_read_b64_tr_b16 a[174:175], v28 offset:15360
    s_waitcnt vmcnt(22)
    s_waitcnt vmcnt(21)
    s_waitcnt lgkmcnt(8)
    v_mfma_f32_32x32x16_bf16 v[96:111], a[144:147], a[88:91], v[96:111]
    ds_read_b64_tr_b16 a[144:145], v27 offset:16384
    ds_read_b64_tr_b16 a[146:147], v27 offset:17408
    v_mfma_f32_32x32x16_bf16 v[112:127], a[148:151], a[88:91], v[112:127]
    ds_read_b64_tr_b16 a[148:149], v28 offset:16384
    ds_read_b64_tr_b16 a[150:151], v28 offset:17408
    v_mfma_f32_32x32x16_bf16 v[96:111], a[152:155], a[92:95], v[96:111]
    ds_read_b64_tr_b16 a[152:153], v27 offset:18432
    ds_read_b64_tr_b16 a[154:155], v27 offset:19456
    v_mfma_f32_32x32x16_bf16 v[112:127], a[156:159], a[92:95], v[112:127]
    ds_read_b64_tr_b16 a[156:157], v28 offset:18432
    ds_read_b64_tr_b16 a[158:159], v28 offset:19456
    s_waitcnt vmcnt(20)
    s_waitcnt vmcnt(19)
    s_waitcnt lgkmcnt(8)
    v_mfma_f32_32x32x16_bf16 v[96:111], a[160:163], a[96:99], v[96:111]
    ds_read_b64_tr_b16 a[160:161], v27 offset:20480
    ds_read_b64_tr_b16 a[162:163], v27 offset:21504
    v_mfma_f32_32x32x16_bf16 v[112:127], a[164:167], a[96:99], v[112:127]
    ds_read_b64_tr_b16 a[164:165], v28 offset:20480
    ds_read_b64_tr_b16 a[166:167], v28 offset:21504
    v_mfma_f32_32x32x16_bf16 v[96:111], a[168:171], a[100:103], v[96:111]
    ds_read_b64_tr_b16 a[168:169], v27 offset:22528
    ds_read_b64_tr_b16 a[170:171], v27 offset:23552
    v_mfma_f32_32x32x16_bf16 v[112:127], a[172:175], a[100:103], v[112:127]
    ds_read_b64_tr_b16 a[172:173], v28 offset:22528
    ds_read_b64_tr_b16 a[174:175], v28 offset:23552
    s_waitcnt vmcnt(18)
    s_waitcnt vmcnt(17)
    s_waitcnt lgkmcnt(8)
    v_mfma_f32_32x32x16_bf16 v[96:111], a[144:147], a[104:107], v[96:111]
    ds_read_b64_tr_b16 a[144:145], v27 offset:24576
    ds_read_b64_tr_b16 a[146:147], v27 offset:25600
    v_mfma_f32_32x32x16_bf16 v[112:127], a[148:151], a[104:107], v[112:127]
    ds_read_b64_tr_b16 a[148:149], v28 offset:24576
    ds_read_b64_tr_b16 a[150:151], v28 offset:25600
    v_mfma_f32_32x32x16_bf16 v[96:111], a[152:155], a[108:111], v[96:111]
    ds_read_b64_tr_b16 a[152:153], v27 offset:26624
    ds_read_b64_tr_b16 a[154:155], v27 offset:27648
    v_mfma_f32_32x32x16_bf16 v[112:127], a[156:159], a[108:111], v[112:127]
    ds_read_b64_tr_b16 a[156:157], v28 offset:26624
    ds_read_b64_tr_b16 a[158:159], v28 offset:27648
    s_waitcnt vmcnt(7)
    s_waitcnt vmcnt(6)
    s_waitcnt lgkmcnt(8)
    v_mfma_f32_32x32x16_bf16 v[96:111], a[160:163], a[112:115], v[96:111]
    ds_read_b64_tr_b16 a[160:161], v27 offset:28672
    ds_read_b64_tr_b16 a[162:163], v27 offset:29696
    v_mfma_f32_32x32x16_bf16 v[112:127], a[164:167], a[112:115], v[112:127]
    ds_read_b64_tr_b16 a[164:165], v28 offset:28672
    ds_read_b64_tr_b16 a[166:167], v28 offset:29696
    v_mfma_f32_32x32x16_bf16 v[96:111], a[168:171], a[116:119], v[96:111]
    ds_read_b64_tr_b16 a[168:169], v27 offset:30720
    ds_read_b64_tr_b16 a[170:171], v27 offset:31744
    v_mfma_f32_32x32x16_bf16 v[112:127], a[172:175], a[116:119], v[112:127]
    ds_read_b64_tr_b16 a[172:173], v28 offset:30720
    ds_read_b64_tr_b16 a[174:175], v28 offset:31744
    s_waitcnt vmcnt(5)
    s_waitcnt vmcnt(4)
    s_waitcnt lgkmcnt(8)
    v_mfma_f32_32x32x16_bf16 v[96:111], a[144:147], a[120:123], v[96:111]
    ds_read_b64_tr_b16 a[144:145], v27 offset:32768
    ds_read_b64_tr_b16 a[146:147], v27 offset:33792
    v_mfma_f32_32x32x16_bf16 v[112:127], a[148:151], a[120:123], v[112:127]
    ds_read_b64_tr_b16 a[148:149], v28 offset:32768
    ds_read_b64_tr_b16 a[150:151], v28 offset:33792
    v_mfma_f32_32x32x16_bf16 v[96:111], a[152:155], a[124:127], v[96:111]
    ds_read_b64_tr_b16 a[152:153], v27 offset:34816
    ds_read_b64_tr_b16 a[154:155], v27 offset:35840
    v_mfma_f32_32x32x16_bf16 v[112:127], a[156:159], a[124:127], v[112:127]
    ds_read_b64_tr_b16 a[156:157], v28 offset:34816
    ds_read_b64_tr_b16 a[158:159], v28 offset:35840
    s_waitcnt vmcnt(3)
    s_waitcnt vmcnt(2)
    s_waitcnt lgkmcnt(8)
    v_mfma_f32_32x32x16_bf16 v[96:111], a[160:163], a[128:131], v[96:111]
    s_cbranch_vccnz W0_17
    s_waitcnt vmcnt(0)
    s_add_u32 s78, s72, 5
    v_subrev_u32 v248, s78, v248
    v_subrev_u32 v249, s78, v249
    v_subrev_u32 v250, s78, v250
    v_subrev_u32 v251, s78, v251
    v_or_b32 v248, v248, v249
    v_or_b32 v250, v250, v251
    v_or_b32 v248, v248, v250
    v_cmp_gt_u32 s[82:83], 8, v248
    s_nop 1
    s_cmp_eq_u64 s[82:83], -1
    s_cbranch_scc0 SLOW5
OK5:
W0_17:
    s_barrier
    ds_read_b64_tr_b16 a[160:161], v29 offset:0
    ds_read_b64_tr_b16 a[162:163], v29 offset:1024
    v_mfma_f32_32x32x16_bf16 v[112:127], a[164:167], a[128:131], v[112:127]
    s_add_u32 s64, s59, 0
    buffer_load_dwordx4 v[32:35], v31, s[20:23], s64 offen sc1
    ds_read_b64_tr_b16 a[164:165], v29 offset:2048
    ds_read_b64_tr_b16 a[166:167], v29 offset:3072
    v_mfma_f32_32x32x16_bf16 v[96:111], a[168:171], a[132:135], v[96:111]
    s_add_u32 s64, s59, 4096
    buffer_load_dwordx4 v[36:39], v31, s[20:23], s64 offen sc1
    ds_read_b64_tr_b16 a[168:169], v29 offset:4096
    ds_read_b64_tr_b16 a[170:171], v29 offset:5120
    v_mfma_f32_32x32x16_bf16 v[112:127], a[172:175], a[132:135], v[112:127]
    s_add_u32 s64, s59, 8192
    buffer_load_dwordx4 v[40:43], v31, s[20:23], s64 offen sc1
    ds_read_b64_tr_b16 a[172:173], v29 offset:6144
    ds_read_b64_tr_b16 a[174:175], v29 offset:7168
    s_waitcnt vmcnt(4)
    s_waitcnt vmcnt(3)
    s_waitcnt lgkmcnt(8)
    v_mfma_f32_32x32x16_bf16 v[96:111], a[144:147], a[136:139], v[96:111]
    s_add_u32 s64, s59, 12288
    buffer_load_dwordx4 v[44:47], v31, s[20:23], s64 offen sc1
    ds_read_b64_tr_b16 a[144:145], v29 offset:8192
    ds_read_b64_tr_b16 a[146:147], v29 offset:9216
    v_mfma_f32_32x32x16_bf16 v[112:127], a[148:151], a[136:139], v[112:127]
    ds_read_b64_tr_b16 a[148:149], v29 offset:10240
    ds_read_b64_tr_b16 a[150:151], v29 offset:11264
    v_mfma_f32_32x32x16_bf16 v[96:111], a[152:155], a[140:143], v[96:111]
    ds_read_b64_tr_b16 a[152:153], v29 offset:12288
    ds_read_b64_tr_b16 a[154:155], v29 offset:13312
    v_mfma_f32_32x32x16_bf16 v[112:127], a[156:159], a[140:143], v[112:127]
    ds_read_b64_tr_b16 a[156:157], v29 offset:14336
    ds_read_b64_tr_b16 a[158:159], v29 offset:15360
    s_waitcnt lgkmcnt(8)
    v_mfma_f32_32x32x16_bf16 v[128:143], a[160:163], a[72:75], v[128:143]
    ds_read_b64_tr_b16 a[160:161], v29 offset:16384
    ds_read_b64_tr_b16 a[162:163], v29 offset:17408
    v_mfma_f32_32x32x16_bf16 v[128:143], a[164:167], a[76:79], v[128:143]
    ds_read_b64_tr_b16 a[164:165], v29 offset:18432
    ds_read_b64_tr_b16 a[166:167], v29 offset:19456
    v_mfma_f32_32x32x16_bf16 v[128:143], a[168:171], a[80:83], v[128:143]
    ds_read_b64_tr_b16 a[168:169], v29 offset:20480
    ds_read_b64_tr_b16 a[170:171], v29 offset:21504
    v_mfma_f32_32x32x16_bf16 v[128:143], a[172:175], a[84:87], v[128:143]
    v_cvt_pk_bf16_f32 v232, v96, v97
    v_cvt_pk_bf16_f32 v233, v98, v99
    ds_read_b64_tr_b16 a[172:173], v29 offset:22528
    ds_read_b64_tr_b16 a[174:175], v29 offset:23552
    s_waitcnt lgkmcnt(8)
    v_mfma_f32_32x32x16_bf16 v[128:143], a[144:147], a[88:91], v[128:143]
    v_cvt_pk_bf16_f32 v234, v100, v101
    v_cvt_pk_bf16_f32 v235, v102, v103
    ds_read_b64_tr_b16 a[144:145], v29 offset:24576
    ds_read_b64_tr_b16 a[146:147], v29 offset:25600
    v_mfma_f32_32x32x16_bf16 v[128:143], a[148:151], a[92:95], v[128:143]
    s_add_u32 s63, s55, 0
    buffer_store_dwordx4 v[232:235], v0, s[20:23], s63 offen sc1
    ds_read_b64_tr_b16 a[148:149], v29 offset:26624
    ds_read_b64_tr_b16 a[150:151], v29 offset:27648
    v_mfma_f32_32x32x16_bf16 v[128:143], a[152:155], a[96:99], v[128:143]
    v_cvt_pk_bf16_f32 v236, v104, v105
    v_cvt_pk_bf16_f32 v237, v106, v107
    ds_read_b64_tr_b16 a[152:153], v29 offset:28672
    ds_read_b64_tr_b16 a[154:155], v29 offset:29696
    v_mfma_f32_32x32x16_bf16 v[128:143], a[156:159], a[100:103], v[128:143]
    v_cvt_pk_bf16_f32 v238, v108, v109
    v_cvt_pk_bf16_f32 v239, v110, v111
    ds_read_b64_tr_b16 a[156:157], v29 offset:30720
    ds_read_b64_tr_b16 a[158:159], v29 offset:31744
    s_waitcnt lgkmcnt(8)
    v_mfma_f32_32x32x16_bf16 v[128:143], a[160:163], a[104:107], v[128:143]
    s_add_u32 s63, s55, 1024
    buffer_store_dwordx4 v[236:239], v0, s[20:23], s63 offen sc1
    ds_read_b64_tr_b16 a[160:161], v29 offset:32768
    ds_read_b64_tr_b16 a[162:163], v29 offset:33792
    v_mfma_f32_32x32x16_bf16 v[128:143], a[164:167], a[108:111], v[128:143]
    v_cvt_pk_bf16_f32 v240, v112, v113
    v_cvt_pk_bf16_f32 v241, v114, v115
    ds_read_b64_tr_b16 a[164:165], v29 offset:34816
    ds_read_b64_tr_b16 a[166:167], v29 offset:35840
    v_mfma_f32_32x32x16_bf16 v[128:143], a[168:171], a[112:115], v[128:143]
    v_cvt_pk_bf16_f32 v242, v116, v117
    v_cvt_pk_bf16_f32 v243, v118, v119
    ds_read_b64_tr_b16 a[168:169], v24 offset:0
    ds_read_b64_tr_b16 a[170:171], v24 offset:1024
    v_mfma_f32_32x32x16_bf16 v[128:143], a[172:175], a[116:119], v[128:143]
    s_add_u32 s63, s56, 0
    buffer_store_dwordx4 v[240:243], v0, s[20:23], s63 offen sc1
    ds_read_b64_tr_b16 a[172:173], v24 offset:2048
    ds_read_b64_tr_b16 a[174:175], v24 offset:3072
    s_waitcnt lgkmcnt(8)
    v_mfma_f32_32x32x16_bf16 v[128:143], a[144:147], a[120:123], v[128:143]
    v_cvt_pk_bf16_f32 v244, v120, v121
    v_cvt_pk_bf16_f32 v245, v122, v123
    ds_read_b64_tr_b16 a[144:145], v24 offset:4096
    ds_read_b64_tr_b16 a[146:147], v24 offset:5120
    v_mfma_f32_32x32x16_bf16 v[128:143], a[148:151], a[124:127], v[128:143]
    v_cvt_pk_bf16_f32 v246, v124, v125
    v_cvt_pk_bf16_f32 v247, v126, v127
    ds_read_b64_tr_b16 a[148:149], v24 offset:6144
    ds_read_b64_tr_b16 a[150:151], v24 offset:7168
    v_mfma_f32_32x32x16_bf16 v[128:143], a[152:155], a[128:131], v[128:143]
    s_add_u32 s63, s56, 1024
    buffer_store_dwordx4 v[244:247], v0, s[20:23], s63 offen sc1
    ds_read_b64_tr_b16 a[152:153], v24 offset:8192
    ds_read_b64_tr_b16 a[154:155], v24 offset:9216
    v_mfma_f32_32x32x16_bf16 v[128:143], a[156:159], a[132:135], v[128:143]
    ds_read_b64_tr_b16 a[156:157], v24 offset:10240
    ds_read_b64_tr_b16 a[158:159], v24 offset:11264
    s_waitcnt lgkmcnt(8)
    v_mfma_f32_32x32x16_bf16 v[128:143], a[160:163], a[136:139], v[128:143]
    ds_read_b64_tr_b16 a[160:161], v24 offset:12288
    ds_read_b64_tr_b16 a[162:163], v24 offset:13312
    v_mfma_f32_32x32x16_bf16 v[128:143], a[164:167], a[140:143], v[128:143]
    ds_read_b64_tr_b16 a[164:165], v24 offset:14336
    ds_read_b64_tr_b16 a[166:167], v24 offset:15360
    v_mfma_f32_32x32x16_bf16 v[144:159], a[168:171], a[176:179], v[144:159]
    ds_read_b64_tr_b16 a[168:169], v24 offset:16384
    ds_read_b64_tr_b16 a[170:171], v24 offset:17408
    v_mfma_f32_32x32x16_bf16 v[144:159], a[172:175], a[180:183], v[144:159]
    ds_read_b64_tr_b16 a[172:173], v24 offset:18432
    ds_read_b64_tr_b16 a[174:175], v24 offset:19456
    s_waitcnt lgkmcnt(8)
    v_mfma_f32_32x32x16_bf16 v[144:159], a[144:147], a[184:187], v[144:159]
    ds_read_b64_tr_b16 a[144:145], v24 offset:20480
    ds_read_b64_tr_b16 a[146:147], v24 offset:21504
    v_mfma_f32_32x32x16_bf16 v[144:159], a[148:151], a[188:191], v[144:159]
    v_cvt_pk_bf16_f32 v232, v128, v129
    v_cvt_pk_bf16_f32 v233, v130, v131
    ds_read_b64_tr_b16 a[148:149], v24 offset:22528
    ds_read_b64_tr_b16 a[150:151], v24 offset:23552
    v_mfma_f32_32x32x16_bf16 v[144:159], a[152:155], a[192:195], v[144:159]
    v_cvt_pk_bf16_f32 v234, v132, v133
    v_cvt_pk_bf16_f32 v235, v134, v135
    ds_read_b64_tr_b16 a[152:153], v24 offset:24576
    ds_read_b64_tr_b16 a[154:155], v24 offset:25600
    v_mfma_f32_32x32x16_bf16 v[144:159], a[156:159], a[196:199], v[144:159]
    s_add_u32 s63, s1, 0
    buffer_store_dwordx4 v[232:235], v0, s[20:23], s63 offen sc1
    s_waitcnt vmcnt(8)
    v_lshlrev_b32 v64, 16, v32
    ds_read_b64_tr_b16 a[156:157], v24 offset:26624
    ds_read_b64_tr_b16 a[158:159], v24 offset:27648
    s_waitcnt lgkmcnt(8)
    v_mfma_f32_32x32x16_bf16 v[144:159], a[160:163], a[200:203], v[144:159]
    v_cvt_pk_bf16_f32 v236, v136, v137
    v_cvt_pk_bf16_f32 v237, v138, v139
    v_and_b32 v65, 0xffff0000, v32
    v_lshlrev_b32 v66, 16, v33
    ds_read_b64_tr_b16 a[160:161], v24 offset:28672
    ds_read_b64_tr_b16 a[162:163], v24 offset:29696
    v_mfma_f32_32x32x16_bf16 v[144:159], a[164:167], a[204:207], v[144:159]
    v_cvt_pk_bf16_f32 v238, v140, v141
    v_cvt_pk_bf16_f32 v239, v142, v143
    v_and_b32 v67, 0xffff0000, v33
    v_lshlrev_b32 v68, 16, v34
    ds_read_b64_tr_b16 a[164:165], v24 offset:30720
    ds_read_b64_tr_b16 a[166:167], v24 offset:31744
    v_mfma_f32_32x32x16_bf16 v[144:159], a[168:171], a[208:211], v[144:159]
    s_add_u32 s63, s1, 1024
    buffer_store_dwordx4 v[236:239], v0, s[20:23], s63 offen sc1
    v_and_b32 v69, 0xffff0000, v34
    v_lshlrev_b32 v70, 16, v35
    ds_read_b64_tr_b16 a[168:169], v24 offset:32768
    ds_read_b64_tr_b16 a[170:171], v24 offset:33792
    v_mfma_f32_32x32x16_bf16 v[144:159], a[172:175], a[212:215], v[144:159]
    v_and_b32 v71, 0xffff0000, v35
    s_waitcnt vmcnt(8)
    ds_read_b64_tr_b16 a[172:173], v24 offset:34816
    ds_read_b64_tr_b16 a[174:175], v24 offset:35840
    s_waitcnt lgkmcnt(8)
    v_mfma_f32_32x32x16_bf16 v[144:159], a[144:147], a[216:219], v[144:159]
    v_lshlrev_b32 v72, 16, v36
    v_and_b32 v73, 0xffff0000, v36
    ds_read_b64_tr_b16 a[144:145], v26 offset:0
    ds_read_b64_tr_b16 a[146:147], v26 offset:1024
    v_mfma_f32_32x32x16_bf16 v[144:159], a[148:151], a[220:223], v[144:159]
    v_add_f32 v64, v64, v72
    v_add_f32 v65, v65, v73
    ds_read_b64_tr_b16 a[148:149], v26 offset:2048
    ds_read_b64_tr_b16 a[150:151], v26 offset:3072
    v_mfma_f32_32x32x16_bf16 v[144:159], a[152:155], a[224:227], v[144:159]
    v_lshlrev_b32 v72, 16, v37
    v_and_b32 v73, 0xffff0000, v37
    ds_read_b64_tr_b16 a[152:153], v26 offset:4096
    ds_read_b64_tr_b16 a[154:155], v26 offset:5120
    v_mfma_f32_32x32x16_bf16 v[144:159], a[156:159], a[228:231], v[144:159]
    v_add_f32 v66, v66, v72
    v_add_f32 v67, v67, v73
    ds_read_b64_tr_b16 a[156:157], v26 offset:6144
    ds_read_b64_tr_b16 a[158:159], v26 offset:7168
    s_waitcnt lgkmcnt(8)
    v_mfma_f32_32x32x16_bf16 v[144:159], a[160:163], a[232:235], v[144:159]
    v_lshlrev_b32 v72, 16, v38
    v_and_b32 v73, 0xffff0000, v38
    ds_read_b64_tr_b16 a[160:161], v26 offset:8192
    ds_read_b64_tr_b16 a[162:163], v26 offset:9216
    v_mfma_f32_32x32x16_bf16 v[144:159], a[164:167], a[236:239], v[144:159]
    v_add_f32 v68, v68, v72
    v_add_f32 v69, v69, v73
    ds_read_b64_tr_b16 a[164:165], v26 offset:10240
    ds_read_b64_tr_b16 a[166:167], v26 offset:11264
    v_mfma_f32_32x32x16_bf16 v[144:159], a[168:171], a[240:243], v[144:159]
    v_lshlrev_b32 v72, 16, v39
    v_and_b32 v73, 0xffff0000, v39
    ds_read_b64_tr_b16 a[168:169], v26 offset:12288
    ds_read_b64_tr_b16 a[170:171], v26 offset:13312
    v_mfma_f32_32x32x16_bf16 v[144:159], a[172:175], a[244:247], v[144:159]
    v_add_f32 v70, v70, v72
    v_add_f32 v71, v71, v73
    ds_read_b64_tr_b16 a[172:173], v26 offset:14336
    ds_read_b64_tr_b16 a[174:175], v26 offset:15360
    s_waitcnt lgkmcnt(8)
    v_mfma_f32_32x32x16_bf16 v[144:159], a[144:147], a[0:3], v[144:159]
    s_waitcnt vmcnt(7)
    v_lshlrev_b32 v72, 16, v40
    ds_read_b64_tr_b16 a[144:145], v26 offset:16384
    ds_read_b64_tr_b16 a[146:147], v26 offset:17408
    v_mfma_f32_32x32x16_bf16 v[144:159], a[148:151], a[4:7], v[144:159]
    v_and_b32 v73, 0xffff0000, v40
    v_add_f32 v64, v64, v72
    ds_read_b64_tr_b16 a[148:149], v26 offset:18432
    ds_read_b64_tr_b16 a[150:151], v26 offset:19456
    v_mfma_f32_32x32x16_bf16 v[144:159], a[152:155], a[8:11], v[144:159]
    v_add_f32 v65, v65, v73
    v_lshlrev_b32 v72, 16, v41
    ds_read_b64_tr_b16 a[152:153], v26 offset:20480
    ds_read_b64_tr_b16 a[154:155], v26 offset:21504
    v_mfma_f32_32x32x16_bf16 v[144:159], a[156:159], a[12:15], v[144:159]
    s_waitcnt vmcnt(0)
    s_barrier
    s_cbranch_vccnz W0_18
    s_add_u32 s78, s72, 6
    v_mov_b32 v252, s78
    buffer_store_dword v252, off, s[20:23], s77 sc1
W0_18:
    v_and_b32 v73, 0xffff0000, v41
    v_add_f32 v66, v66, v72
    ds_read_b64_tr_b16 a[156:157], v26 offset:22528
    ds_read_b64_tr_b16 a[158:159], v26 offset:23552
    s_waitcnt lgkmcnt(8)
    v_mfma_f32_32x32x16_bf16 v[144:159], a[160:163], a[16:19], v[144:159]
    v_add_f32 v67, v67, v73
    v_lshlrev_b32 v72, 16, v42
    ds_read_b64_tr_b16 a[160:161], v26 offset:24576
    ds_read_b64_tr_b16 a[162:163], v26 offset:25600
    v_mfma_f32_32x32x16_bf16 v[144:159], a[164:167], a[20:23], v[144:159]
    v_and_b32 v73, 0xffff0000, v42
    v_add_f32 v68, v68, v72
    ds_read_b64_tr_b16 a[164:165], v26 offset:26624
    ds_read_b64_tr_b16 a[166:167], v26 offset:27648
    v_mfma_f32_32x32x16_bf16 v[144:159], a[168:171], a[24:27], v[144:159]
    v_add_f32 v69, v69, v73
    v_lshlrev_b32 v72, 16, v43
    ds_read_b64_tr_b16 a[168:169], v26 offset:28672
    ds_read_b64_tr_b16 a[170:171], v26 offset:29696
    v_mfma_f32_32x32x16_bf16 v[144:159], a[172:175], a[28:31], v[144:159]
    v_and_b32 v73, 0xffff0000, v43
    v_add_f32 v70, v70, v72
    ds_read_b64_tr_b16 a[172:173], v26 offset:30720
    ds_read_b64_tr_b16 a[174:175], v26 offset:31744
    s_waitcnt lgkmcnt(8)
    v_mfma_f32_32x32x16_bf16 v[144:159], a[144:147], a[32:35], v[144:159]
    v_add_f32 v71, v71, v73
    ds_read_b64_tr_b16 a[144:145], v26 offset:32768
    ds_read_b64_tr_b16 a[146:147], v26 offset:33792
    v_mfma_f32_32x32x16_bf16 v[144:159], a[148:151], a[36:39], v[144:159]
    v_lshlrev_b32 v72, 16, v44
    v_and_b32 v73, 0xffff0000, v44
    ds_read_b64_tr_b16 a[148:149], v26 offset:34816
    ds_read_b64_tr_b16 a[150:151], v26 offset:35840
    v_mfma_f32_32x32x16_bf16 v[144:159], a[152:155], a[40:43], v[144:159]
    v_add_f32 v64, v64, v72
    v_add_f32 v65, v65, v73
    ds_read_b64_tr_b16 a[152:153], v30 offset:0
    ds_read_b64_tr_b16 a[154:155], v30 offset:1024
    v_mfma_f32_32x32x16_bf16 v[144:159], a[156:159], a[44:47], v[144:159]
    v_lshlrev_b32 v72, 16, v45
    v_and_b32 v73, 0xffff0000, v45
    ds_read_b64_tr_b16 a[156:157], v30 offset:2048
    ds_read_b64_tr_b16 a[158:159], v30 offset:3072
    s_waitcnt lgkmcnt(8)
    v_mfma_f32_32x32x16_bf16 v[144:159], a[160:163], a[48:51], v[144:159]
    v_add_f32 v66, v66, v72
    v_add_f32 v67, v67, v73
    ds_read_b64_tr_b16 a[160:161], v30 offset:4096
    ds_read_b64_tr_b16 a[162:163], v30 offset:5120
    v_mfma_f32_32x32x16_bf16 v[144:159], a[164:167], a[52:55], v[144:159]
    v_lshlrev_b32 v72, 16, v46
    v_and_b32 v73, 0xffff0000, v46
    ds_read_b64_tr_b16 a[164:165], v30 offset:6144
    ds_read_b64_tr_b16 a[166:167], v30 offset:7168
    v_mfma_f32_32x32x16_bf16 v[144:159], a[168:171], a[56:59], v[144:159]
    v_add_f32 v68, v68, v72
    v_add_f32 v69, v69, v73
    ds_read_b64_tr_b16 a[168:169], v30 offset:8192
    ds_read_b64_tr_b16 a[170:171], v30 offset:9216
    v_mfma_f32_32x32x16_bf16 v[144:159], a[172:175], a[60:63], v[144:159]
    v_lshlrev_b32 v72, 16, v47
    v_and_b32 v73, 0xffff0000, v47
    ds_read_b64_tr_b16 a[172:173], v30 offset:10240
    ds_read_b64_tr_b16 a[174:175], v30 offset:11264
    s_waitcnt lgkmcnt(8)
    v_mfma_f32_32x32x16_bf16 v[144:159], a[144:147], a[64:67], v[144:159]
    v_add_f32 v70, v70, v72
    v_add_f32 v71, v71, v73
    ds_read_b64_tr_b16 a[144:145], v30 offset:12288
    ds_read_b64_tr_b16 a[146:147], v30 offset:13312
    v_mfma_f32_32x32x16_bf16 v[144:159], a[148:151], a[68:71], v[144:159]
    v_nop
    v_nop
    ds_read_b64_tr_b16 a[148:149], v30 offset:14336
    ds_read_b64_tr_b16 a[150:151], v30 offset:15360
    v_mfma_f32_32x32x16_bf16 v[144:159], a[152:155], a[72:75], v[144:159]
    v_permlane32_swap_b32 v64, v68
    v_permlane32_swap_b32 v65, v69
    ds_read_b64_tr_b16 a[152:153], v30 offset:16384
    ds_read_b64_tr_b16 a[154:155], v30 offset:17408
    v_mfma_f32_32x32x16_bf16 v[144:159], a[156:159], a[76:79], v[144:159]
    v_permlane32_swap_b32 v66, v70
    v_permlane32_swap_b32 v67, v71
    ds_read_b64_tr_b16 a[156:157], v30 offset:18432
    ds_read_b64_tr_b16 a[158:159], v30 offset:19456
    s_waitcnt lgkmcnt(8)
    v_mfma_f32_32x32x16_bf16 v[144:159], a[160:163], a[80:83], v[144:159]
    v_add_f32 v64, v64, v68
    v_add_f32 v65, v65, v69
    ds_read_b64_tr_b16 a[160:161], v30 offset:20480
    ds_read_b64_tr_b16 a[162:163], v30 offset:21504
    v_mfma_f32_32x32x16_bf16 v[144:159], a[164:167], a[84:87], v[144:159]
    v_add_f32 v66, v66, v70
    v_add_f32 v67, v67, v71
    ds_read_b64_tr_b16 a[164:165], v30 offset:22528
    ds_read_b64_tr_b16 a[166:167], v30 offset:23552
    v_mfma_f32_32x32x16_bf16 v[144:159], a[168:171], a[88:91], v[144:159]
    v_nop
    v_nop
    ds_read_b64_tr_b16 a[168:169], v30 offset:24576
    ds_read_b64_tr_b16 a[170:171], v30 offset:25600
    v_mfma_f32_32x32x16_bf16 v[144:159], a[172:175], a[92:95], v[144:159]
    v_permlane16_swap_b32 v64, v66
    v_permlane16_swap_b32 v65, v67
    ds_read_b64_tr_b16 a[172:173], v30 offset:26624
    ds_read_b64_tr_b16 a[174:175], v30 offset:27648
    s_waitcnt lgkmcnt(8)
    v_mfma_f32_32x32x16_bf16 v[144:159], a[144:147], a[96:99], v[144:159]
    v_add_f32 v64, v64, v66
    v_add_f32 v65, v65, v67
    ds_read_b64_tr_b16 a[144:145], v30 offset:28672
    ds_read_b64_tr_b16 a[146:147], v30 offset:29696
    v_mfma_f32_32x32x16_bf16 v[144:159], a[148:151], a[100:103], v[144:159]
    s_cbranch_vccnz W0_19
    buffer_load_dwordx4 v[248:251], off, s[20:23], s75 sc1
W0_19:
    v_cvt_pk_bf16_f32 v68, v64, v65
    buffer_store_dword v68, v12, s[24:27], s61 offen
    ds_read_b64_tr_b16 a[148:149], v30 offset:30720
    ds_read_b64_tr_b16 a[150:151], v30 offset:31744
    v_mfma_f32_32x32x16_bf16 v[144:159], a[152:155], a[104:107], v[144:159]
    ds_read_b64_tr_b16 a[152:153], v30 offset:32768
    ds_read_b64_tr_b16 a[154:155], v30 offset:33792
    v_mfma_f32_32x32x16_bf16 v[144:159], a[156:159], a[108:111], v[144:159]
    ds_read_b64_tr_b16 a[156:157], v30 offset:34816
    ds_read_b64_tr_b16 a[158:159], v30 offset:35840
    s_waitcnt lgkmcnt(8)
    v_mfma_f32_32x32x16_bf16 v[144:159], a[160:163], a[112:115], v[144:159]
    v_mfma_f32_32x32x16_bf16 v[144:159], a[164:167], a[116:119], v[144:159]
    v_mfma_f32_32x32x16_bf16 v[144:159], a[168:171], a[120:123], v[144:159]
    v_mfma_f32_32x32x16_bf16 v[144:159], a[172:175], a[124:127], v[144:159]
    s_waitcnt lgkmcnt(0)
    v_mfma_f32_32x32x16_bf16 v[144:159], a[144:147], a[128:131], v[144:159]
    v_mfma_f32_32x32x16_bf16 v[144:159], a[148:151], a[132:135], v[144:159]
    v_mfma_f32_32x32x16_bf16 v[144:159], a[152:155], a[136:139], v[144:159]
    v_mfma_f32_32x32x16_bf16 v[144:159], a[156:159], a[140:143], v[144:159]
    s_cbranch_vccnz W0_20
    s_mov_b32 s71, 0
    s_waitcnt vmcnt(0)
    s_add_u32 s78, s72, 6
    v_subrev_u32 v248, s78, v248
    v_subrev_u32 v249, s78, v249
    v_subrev_u32 v250, s78, v250
    v_subrev_u32 v251, s78, v251
    v_or_b32 v248, v248, v249
    v_or_b32 v250, v250, v251
    v_or_b32 v248, v248, v250
    v_cmp_gt_u32 s[82:83], 8, v248
    s_nop 1
    s_cmp_eq_u64 s[82:83], -1
    s_cbranch_scc1 FINAL_GO
FINAL_LOOP:
    buffer_load_dwordx4 v[248:251], off, s[20:23], s75 sc1
    s_waitcnt vmcnt(0)
    s_add_u32 s78, s72, 6
    v_subrev_u32 v248, s78, v248
    v_subrev_u32 v249, s78, v249
    v_subrev_u32 v250, s78, v250
    v_subrev_u32 v251, s78, v251
    v_or_b32 v248, v248, v249
    v_or_b32 v250, v250, v251
    v_or_b32 v248, v248, v250
    v_cmp_gt_u32 s[82:83], 8, v248
    s_nop 1
    s_cmp_eq_u64 s[82:83], -1
    s_cbranch_scc1 FINAL_GO
    s_add_u32 s71, s71, 1
    s_cmp_lt_u32 s71, 200000
    s_cbranch_scc1 FINAL_LOOP
FINAL_GO:
W0_20:
    s_barrier
    s_add_u32 s67, s35, 1
    s_and_b32 s67, s67, 3
    s_lshl_b32 s67, s67, 13
    s_add_u32 s64, s58, s67
    buffer_load_dwordx4 v[32:35], v0, s[20:23], s64 offen offset:0 sc1
    buffer_load_dwordx4 v[36:39], v0, s[20:23], s64 offen offset:1024 sc1
    s_add_u32 s67, s35, 2
    s_and_b32 s67, s67, 3
    s_lshl_b32 s67, s67, 13
    s_add_u32 s64, s58, s67
    buffer_load_dwordx4 v[40:43], v0, s[20:23], s64 offen offset:0 sc1
    buffer_load_dwordx4 v[44:47], v0, s[20:23], s64 offen offset:1024 sc1
    s_add_u32 s67, s35, 3
    s_and_b32 s67, s67, 3
    s_lshl_b32 s67, s67, 13
    s_add_u32 s64, s58, s67
    buffer_load_dwordx4 v[48:51], v0, s[20:23], s64 offen offset:0 sc1
    buffer_load_dwordx4 v[52:55], v0, s[20:23], s64 offen offset:1024 sc1
    s_nop 7
    s_nop 3
    s_waitcnt vmcnt(5)
    v_lshlrev_b32 v64, 16, v32
    v_and_b32 v65, 0xffff0000, v32
    v_add_f32 v144, v144, v64
    v_add_f32 v145, v145, v65
    v_lshlrev_b32 v64, 16, v33
    v_and_b32 v65, 0xffff0000, v33
    v_add_f32 v146, v146, v64
    v_add_f32 v147, v147, v65
    v_lshlrev_b32 v64, 16, v34
    v_and_b32 v65, 0xffff0000, v34
    v_add_f32 v148, v148, v64
    v_add_f32 v149, v149, v65
    v_lshlrev_b32 v64, 16, v35
    v_and_b32 v65, 0xffff0000, v35
    v_add_f32 v150, v150, v64
    v_add_f32 v151, v151, v65
    s_waitcnt vmcnt(4)
    v_lshlrev_b32 v64, 16, v36
    v_and_b32 v65, 0xffff0000, v36
    v_add_f32 v152, v152, v64
    v_add_f32 v153, v153, v65
    v_lshlrev_b32 v64, 16, v37
    v_and_b32 v65, 0xffff0000, v37
    v_add_f32 v154, v154, v64
    v_add_f32 v155, v155, v65
    v_lshlrev_b32 v64, 16, v38
    v_and_b32 v65, 0xffff0000, v38
    v_add_f32 v156, v156, v64
    v_add_f32 v157, v157, v65
    v_lshlrev_b32 v64, 16, v39
    v_and_b32 v65, 0xffff0000, v39
    v_add_f32 v158, v158, v64
    v_add_f32 v159, v159, v65
    s_waitcnt vmcnt(3)
    v_lshlrev_b32 v64, 16, v40
    v_and_b32 v65, 0xffff0000, v40
    v_add_f32 v144, v144, v64
    v_add_f32 v145, v145, v65
    v_lshlrev_b32 v64, 16, v41
    v_and_b32 v65, 0xffff0000, v41
    v_add_f32 v146, v146, v64
    v_add_f32 v147, v147, v65
    v_lshlrev_b32 v64, 16, v42
    v_and_b32 v65, 0xffff0000, v42
    v_add_f32 v148, v148, v64
    v_add_f32 v149, v149, v65
    v_lshlrev_b32 v64, 16, v43
    v_and_b32 v65, 0xffff0000, v43
    v_add_f32 v150, v150, v64
    v_add_f32 v151, v151, v65
    s_waitcnt vmcnt(2)
    v_lshlrev_b32 v64, 16, v44
    v_and_b32 v65, 0xffff0000, v44
    v_add_f32 v152, v152, v64
    v_add_f32 v153, v153, v65
    v_lshlrev_b32 v64, 16, v45
    v_and_b32 v65, 0xffff0000, v45
    v_add_f32 v154, v154, v64
    v_add_f32 v155, v155, v65
    v_lshlrev_b32 v64, 16, v46
    v_and_b32 v65, 0xffff0000, v46
    v_add_f32 v156, v156, v64
    v_add_f32 v157, v157, v65
    v_lshlrev_b32 v64, 16, v47
    v_and_b32 v65, 0xffff0000, v47
    v_add_f32 v158, v158, v64
    v_add_f32 v159, v159, v65
    s_waitcnt vmcnt(1)
    v_lshlrev_b32 v64, 16, v48
    v_and_b32 v65, 0xffff0000, v48
    v_add_f32 v144, v144, v64
    v_add_f32 v145, v145, v65
    v_lshlrev_b32 v64, 16, v49
    v_and_b32 v65, 0xffff0000, v49
    v_add_f32 v146, v146, v64
    v_add_f32 v147, v147, v65
    v_lshlrev_b32 v64, 16, v50
    v_and_b32 v65, 0xffff0000, v50
    v_add_f32 v148, v148, v64
    v_add_f32 v149, v149, v65
    v_lshlrev_b32 v64, 16, v51
    v_and_b32 v65, 0xffff0000, v51
    v_add_f32 v150, v150, v64
    v_add_f32 v151, v151, v65
    s_waitcnt vmcnt(0)
    v_lshlrev_b32 v64, 16, v52
    v_and_b32 v65, 0xffff0000, v52
    v_add_f32 v152, v152, v64
    v_add_f32 v153, v153, v65
    v_lshlrev_b32 v64, 16, v53
    v_and_b32 v65, 0xffff0000, v53
    v_add_f32 v154, v154, v64
    v_add_f32 v155, v155, v65
    v_lshlrev_b32 v64, 16, v54
    v_and_b32 v65, 0xffff0000, v54
    v_add_f32 v156, v156, v64
    v_add_f32 v157, v157, v65
    v_lshlrev_b32 v64, 16, v55
    v_and_b32 v65, 0xffff0000, v55
    v_add_f32 v158, v158, v64
    v_add_f32 v159, v159, v65
    v_cvt_pk_bf16_f32 v68, v144, v145
    v_cvt_pk_bf16_f32 v69, v146, v147
    v_cvt_pk_bf16_f32 v70, v148, v149
    v_cvt_pk_bf16_f32 v71, v150, v151
    s_nop 1
    v_permlane32_swap_b32 v68, v70
    v_permlane32_swap_b32 v69, v71
    s_add_u32 s63, s60, 0
    buffer_store_dwordx4 v[68:71], v11, s[24:27], s63 offen
    v_cvt_pk_bf16_f32 v72, v152, v153
    v_cvt_pk_bf16_f32 v73, v154, v155
    v_cvt_pk_bf16_f32 v74, v156, v157
    v_cvt_pk_bf16_f32 v75, v158, v159
    s_nop 1
    v_permlane32_swap_b32 v72, v74
    v_permlane32_swap_b32 v73, v75
    s_add_u32 s63, s60, 32
    buffer_store_dwordx4 v[72:75], v11, s[24:27], s63 offen
K1_END:
    s_endpgm
SLOW0:
    s_mov_b32 s71, 0
SLOWL0:
    s_sleep 1
    buffer_load_dword v248, off, s[28:31], 0 sc1
    s_waitcnt vmcnt(0)
    v_readfirstlane_b32 s72, v248
    s_nop 0
    s_cmp_lg_u32 s72, 0
    s_cbranch_scc1 OK0
    s_add_u32 s71, s71, 1
    s_cmp_lt_u32 s71, 200000
    s_cbranch_scc1 SLOWL0
    s_branch OK0
SLOW1:
    s_mov_b32 s71, 0
SLOWL1:
    s_sleep 1
    buffer_load_dwordx4 v[248:251], off, s[20:23], s73 sc1
    s_waitcnt vmcnt(0)
    s_add_u32 s78, s72, 1
    v_subrev_u32 v248, s78, v248
    v_subrev_u32 v249, s78, v249
    v_subrev_u32 v250, s78, v250
    v_subrev_u32 v251, s78, v251
    v_or_b32 v248, v248, v249
    v_or_b32 v250, v250, v251
    v_or_b32 v248, v248, v250
    v_cmp_gt_u32 s[82:83], 8, v248
    s_nop 1
    s_cmp_eq_u64 s[82:83], -1
    s_cbranch_scc1 OK1
    s_add_u32 s71, s71, 1
    s_cmp_lt_u32 s71, 200000
    s_cbranch_scc1 SLOWL1
    s_branch OK1
SLOW2:
    s_mov_b32 s71, 0
SLOWL2:
    s_sleep 1
    buffer_load_dwordx4 v[248:251], off, s[20:23], s73 sc1
    s_waitcnt vmcnt(0)
    s_add_u32 s78, s72, 2
    v_subrev_u32 v248, s78, v248
    v_subrev_u32 v249, s78, v249
    v_subrev_u32 v250, s78, v250
    v_subrev_u32 v251, s78, v251
    v_or_b32 v248, v248, v249
    v_or_b32 v250, v250, v251
    v_or_b32 v248, v248, v250
    v_cmp_gt_u32 s[82:83], 8, v248
    s_nop 1
    s_cmp_eq_u64 s[82:83], -1
    s_cbranch_scc1 OK2
    s_add_u32 s71, s71, 1
    s_cmp_lt_u32 s71, 200000
    s_cbranch_scc1 SLOWL2
    s_branch OK2
SLOW3:
    s_mov_b32 s71, 0
SLOWL3:
    s_sleep 1
    buffer_load_dwordx4 v[248:251], off, s[20:23], s73 sc1
    s_waitcnt vmcnt(0)
    s_add_u32 s78, s72, 3
    v_subrev_u32 v248, s78, v248
    v_subrev_u32 v249, s78, v249
    v_subrev_u32 v250, s78, v250
    v_subrev_u32 v251, s78, v251
    v_or_b32 v248, v248, v249
    v_or_b32 v250, v250, v251
    v_or_b32 v248, v248, v250
    v_cmp_gt_u32 s[82:83], 8, v248
    s_nop 1
    s_cmp_eq_u64 s[82:83], -1
    s_cbranch_scc1 OK3
    s_add_u32 s71, s71, 1
    s_cmp_lt_u32 s71, 200000
    s_cbranch_scc1 SLOWL3
    s_branch OK3
SLOW4:
    s_mov_b32 s71, 0
SLOWL4:
    s_sleep 1
    buffer_load_dwordx4 v[248:251], off, s[20:23], s73 sc1
    s_waitcnt vmcnt(0)
    s_add_u32 s78, s72, 4
    v_subrev_u32 v248, s78, v248
    v_subrev_u32 v249, s78, v249
    v_subrev_u32 v250, s78, v250
    v_subrev_u32 v251, s78, v251
    v_or_b32 v248, v248, v249
    v_or_b32 v250, v250, v251
    v_or_b32 v248, v248, v250
    v_cmp_gt_u32 s[82:83], 8, v248
    s_nop 1
    s_cmp_eq_u64 s[82:83], -1
    s_cbranch_scc1 OK4
    s_add_u32 s71, s71, 1
    s_cmp_lt_u32 s71, 200000
    s_cbranch_scc1 SLOWL4
    s_branch OK4
SLOW5:
    s_mov_b32 s71, 0
SLOWL5:
    s_sleep 1
    buffer_load_dwordx4 v[248:251], v254, s[20:23], s74 offen sc1
    s_waitcnt vmcnt(0)
    s_add_u32 s78, s72, 5
    v_subrev_u32 v248, s78, v248
    v_subrev_u32 v249, s78, v249
    v_subrev_u32 v250, s78, v250
    v_subrev_u32 v251, s78, v251
    v_or_b32 v248, v248, v249
    v_or_b32 v250, v250, v251
    v_or_b32 v248, v248, v250
    v_cmp_gt_u32 s[82:83], 8, v248
    s_nop 1
    s_cmp_eq_u64 s[82:83], -1
    s_cbranch_scc1 OK5
    s_add_u32 s71, s71, 1
    s_cmp_lt_u32 s71, 200000
    s_cbranch_scc1 SLOWL5
    s_branch OK5
CODE_END:
.section .rodata,"a"
.p2align 6
.amdhsa_kernel standalone__glu_gated_reglu__prompt_kernel
  .amdhsa_next_free_vgpr 512
  .amdhsa_next_free_sgpr 102
  .amdhsa_accum_offset 256
  .amdhsa_group_segment_fixed_size 0
  .amdhsa_kernarg_size 56
  .amdhsa_user_sgpr_count 2
  .amdhsa_user_sgpr_kernarg_segment_ptr 1
  .amdhsa_system_sgpr_workgroup_id_x 1
.end_amdhsa_kernel
```
